```python
import torch

def _softmax(x, axis=-1):
    return torch.softmax(x, dim=axis)
def _gelu(x):
    return torch.nn.functional.gelu(x, approximate="tanh")
def _silu(x):
    return torch.nn.functional.silu(x)
def _sigmoid(x):
    return torch.sigmoid(x)
def _layernorm(x, axis=-1, eps=1e-5):
    m = x.mean(dim=axis, keepdim=True)
    v = x.var(dim=axis, keepdim=True, unbiased=False)
    return (x - m) / torch.sqrt(v + eps)
def _scatter_add(tgt, idx, src, axis=0):
    return tgt.clone().index_add_(axis, idx, src)
def _segment_sum(src, seg, n):
    out = torch.zeros((n,) + src.shape[1:], dtype=src.dtype)
    return out.index_add_(0, seg, src)
def _pad(x, pw):
    flat = tuple(v for pair in reversed(pw) for v in pair)
    return torch.nn.functional.pad(x, flat)

kernel_name = 'standalone__dense_activation_relu__prompt'

def setup_inputs():

    _w = (lambda a: (lambda t: t.to(torch.bfloat16) if t.is_floating_point() else t)(torch.as_tensor(a)))
    B, S, D, Dff = 1, 2048, 1024, 3584
    return {
        "x": _w((lambda *s: torch.randn(*s, dtype=torch.bfloat16) * 0.05)(B, S, D)),
        "w1": _w((lambda *s: torch.randn(*s, dtype=torch.bfloat16) * 0.05)(D, Dff)),
        "w2": _w((lambda *s: torch.randn(*s, dtype=torch.bfloat16) * 0.05)(Dff, D)),
    }

def reference(x, w1, w2):
    h = torch.einsum("bsd,df->bsf", x, w1)
    zero = torch.zeros_like(h)
    h = torch.maximum(h, zero)
    return torch.einsum("bsf,fd->bsd", h, w2)
```

```asm
; @launch grid=(256,1,1) block=(512,1,1) lds=163840
.amdgcn_target "amdgcn-amd-amdhsa--gfx950"
.text
.globl standalone__dense_activation_relu__prompt_kernel
.p2align 8
.type standalone__dense_activation_relu__prompt_kernel,@function
standalone__dense_activation_relu__prompt_kernel:
    s_cmp_ge_u32 s2, 256
    s_cbranch_scc1 L_end
    s_load_dwordx8 s[80:87], s[0:1], 0
    s_load_dwordx4 s[4:7], s[0:1], 32
    s_bfe_u32 s3, s2, 0x10003
    s_bfe_u32 s10, s2, 0x40004
    s_and_b32 s2, s2, 7
    s_lshl_b32 s3, s3, 7
    s_lshl_b32 s10, s10, 3
    s_or_b32 s2, s2, s3
    s_or_b32 s2, s2, s10
    s_getpc_b64 s[42:43]
L_pc0:
    s_lshl_b32 s30, s2, 3
    s_andn2_b32 s30, s30, 63
    s_load_dword s101, s[42:43], s30
    v_lshrrev_b32 v1, 6, v0
    v_and_b32 v0, 63, v0
    s_and_b32 s10, s2, 7
    v_readfirstlane_b32 s12, v1
    s_lshr_b32 s11, s2, 3
    s_and_b32 s13, s10, 3
    s_lshl_b32 s13, s13, 2
    s_and_b32 s14, s11, 3
    s_add_u32 s13, s13, s14
    s_lshr_b32 s41, s10, 2
    s_lshr_b32 s10, s11, 4
    s_xor_b32 s14, s41, s10
    s_lshl_b32 s14, s14, 2
    s_lshr_b32 s11, s11, 2
    s_and_b32 s11, s11, 3
    s_add_u32 s11, s11, s14
    s_mul_i32 s15, s13, 921600
    s_add_u32 s48, s15, 917504
    s_lshl_b32 s49, s13, 4
    s_cmp_lt_u32 s12, 4
    s_cbranch_scc1 L_cons
L_prod:
    s_setprio 3
    s_sub_u32 s3, s12, 4
    s_add_u32 s40, s13, s11
    s_and_b32 s40, s40, 3
    v_lshrrev_b32 v1, 3, v0
    v_and_b32 v2, 7, v0
    v_lshrrev_b32 v3, 4, v0
    v_xor_b32 v2, v2, v3
    s_lshl_b32 s28, s13, 7
    s_lshl_b32 s29, s3, 5
    s_add_u32 s28, s28, s29
    v_add_u32 v1, s28, v1
    v_lshlrev_b32 v1, 11, v1
    v_lshl_add_u32 v8, v2, 4, v1
    v_xor_b32 v9, 64, v8
    v_add_u32 v9, 15360, v9
    v_add_u32 v10, 30720, v8
    v_add_u32 v11, 30720, v9
    s_lshl_b32 s30, s3, 12
    s_mul_i32 s28, s3, 114688
    s_movk_i32 s29, 7168
    s_add_u32 m0, s30, 49152
    s_mov_b32 s59, 0
    s_lshl_b32 s32, s59, 7
    s_mul_i32 s33, s59, 458752
    s_mov_b32 s18, 4194304
    s_mov_b32 s19, 0x20000
    s_mov_b32 s22, 7340032
    s_mov_b32 s23, 0x20000
    s_cmp_eq_u32 s10, 1
    s_cbranch_scc0 L_p1F
L_p1H:
    v_lshrrev_b32 v1, 5, v0
    v_and_b32 v2, 31, v0
    v_lshlrev_b32 v4, 1, v1
    v_xor_b32 v2, v2, v4
    v_mul_u32_u24 v1, s29, v1
    v_lshl_add_u32 v1, v2, 4, v1
    s_lshl_b32 s31, s11, 9
    s_add_u32 s31, s31, s28
    s_add_u32 s31, s31, 3072
    v_add_u32 v12, s31, v1
    v_xor_b32 v13, 64, v12
    v_add_u32 v13, 13312, v13
    v_xor_b32 v14, 0, v12
    v_add_u32 v14, 26624, v14
    v_xor_b32 v15, 64, v12
    v_add_u32 v15, 39936, v15
    v_xor_b32 v16, 128, v12
    v_add_u32 v16, 57344, v16
    v_xor_b32 v17, 192, v12
    v_add_u32 v17, 70656, v17
    v_xor_b32 v18, 128, v12
    v_add_u32 v18, 83968, v18
    v_xor_b32 v19, 192, v12
    v_add_u32 v19, 97280, v19
    s_mov_b32 s97, 6
    s_lshl_b32 s34, s13, 2
    s_add_u32 s34, s34, s3
    s_lshl_b32 s34, s34, 13
    s_mul_i32 s31, s11, 524544
    s_add_u32 s34, s34, s31
    s_add_u32 s34, s34, 3145728
    s_mul_i32 s31, s3, 4096
    s_add_u32 s31, s31, 16384
    s_waitcnt lgkmcnt(0)
    s_mov_b32 s16, s80
    s_and_b32 s17, s81, 0xffff
    s_mov_b32 s20, s82
    s_and_b32 s21, s83, 0xffff
    buffer_load_dwordx4 v8, s[16:19], s32 offen offset:0 lds
    buffer_load_dwordx4 v9, s[16:19], s32 offen offset:1024 lds
    buffer_load_dwordx4 v10, s[16:19], s32 offen offset:2048 lds
    buffer_load_dwordx4 v11, s[16:19], s32 offen offset:3072 lds
    s_add_u32 m0, m0, s31
    s_mov_b32 s8, s6
    buffer_load_dwordx4 v12, s[20:23], s33 offen offset:0 lds
    buffer_load_dwordx4 v13, s[20:23], s33 offen offset:1024 lds
    buffer_load_dwordx4 v14, s[20:23], s33 offen offset:2048 lds
    buffer_load_dwordx4 v15, s[20:23], s33 offen offset:3072 lds
    s_add_u32 m0, m0, 4096
    s_mov_b32 s9, s7
    buffer_load_dwordx4 v16, s[20:23], s33 offen offset:0 lds
    buffer_load_dwordx4 v17, s[20:23], s33 offen offset:1024 lds
    buffer_load_dwordx4 v18, s[20:23], s33 offen offset:2048 lds
    buffer_load_dwordx4 v19, s[20:23], s33 offen offset:3072 lds
    s_branch L_restH
L_p1F:
    s_mul_i32 s31, s11, 384
    s_add_u32 s31, s31, s28
    v_add_u32 v1, 0, v0
    v_mul_u32_u24 v2, 2731, v1
    v_lshrrev_b32 v2, 16, v2
    v_mul_u32_u24 v4, 24, v2
    v_sub_u32 v4, v1, v4
    v_and_b32 v5, 2, v2
    v_xor_b32 v4, v4, v5
    v_mul_u32_u24 v2, s29, v2
    v_add_u32 v2, s31, v2
    v_lshl_add_u32 v12, v4, 4, v2
    v_xor_b32 v4, 4, v4
    v_lshl_add_u32 v15, v4, 4, v2
    v_add_u32 v15, 54272, v15
    v_add_u32 v1, 64, v0
    v_mul_u32_u24 v2, 2731, v1
    v_lshrrev_b32 v2, 16, v2
    v_mul_u32_u24 v4, 24, v2
    v_sub_u32 v4, v1, v4
    v_and_b32 v5, 2, v2
    v_xor_b32 v4, v4, v5
    v_mul_u32_u24 v2, s29, v2
    v_add_u32 v2, s31, v2
    v_lshl_add_u32 v13, v4, 4, v2
    v_xor_b32 v4, 4, v4
    v_lshl_add_u32 v16, v4, 4, v2
    v_subrev_u32 v13, 1024, v13
    v_add_u32 v16, 57344, v16
    v_add_u32 v1, 128, v0
    v_mul_u32_u24 v2, 2731, v1
    v_lshrrev_b32 v2, 16, v2
    v_mul_u32_u24 v4, 24, v2
    v_sub_u32 v4, v1, v4
    v_and_b32 v5, 2, v2
    v_xor_b32 v4, v4, v5
    v_mul_u32_u24 v2, s29, v2
    v_add_u32 v2, s31, v2
    v_lshl_add_u32 v14, v4, 4, v2
    v_xor_b32 v4, 4, v4
    v_lshl_add_u32 v17, v4, 4, v2
    v_subrev_u32 v14, 2048, v14
    v_add_u32 v17, 56320, v17
    s_mul_i32 s31, s3, 2048
    s_add_u32 s31, s31, 16384
    s_waitcnt lgkmcnt(0)
    s_mov_b32 s16, s80
    s_and_b32 s17, s81, 0xffff
    s_mov_b32 s20, s82
    s_and_b32 s21, s83, 0xffff
    buffer_load_dwordx4 v8, s[16:19], s32 offen offset:0 lds
    buffer_load_dwordx4 v9, s[16:19], s32 offen offset:1024 lds
    buffer_load_dwordx4 v10, s[16:19], s32 offen offset:2048 lds
    buffer_load_dwordx4 v11, s[16:19], s32 offen offset:3072 lds
    s_add_u32 m0, m0, s31
    s_mov_b32 s8, s6
    buffer_load_dwordx4 v12, s[20:23], s33 offen offset:0 lds
    buffer_load_dwordx4 v13, s[20:23], s33 offen offset:1024 lds
    buffer_load_dwordx4 v14, s[20:23], s33 offen offset:2048 lds
    buffer_load_dwordx4 v15, s[20:23], s33 offen offset:3072 lds
    s_add_u32 m0, m0, 4096
    s_mov_b32 s9, s7
    buffer_load_dwordx4 v16, s[20:23], s33 offen offset:0 lds
    buffer_load_dwordx4 v17, s[20:23], s33 offen offset:1024 lds
    s_mov_b32 s36, 1750348304
    s_mov_b32 s37, 4275809431
    s_cmp_eq_u32 s40, 1
    s_cselect_b32 s36, 2522100240, s36
    s_cselect_b32 s37, 4274772615, s37
    s_cmp_eq_u32 s40, 2
    s_cselect_b32 s36, 1985229328, s36
    s_cselect_b32 s37, 4258183562, s37
    s_cmp_eq_u32 s40, 3
    s_cselect_b32 s36, 1702113808, s36
    s_cselect_b32 s37, 3992758712, s37
    v_lshlrev_b32 v7, 2, v0
    v_lshrrev_b64 v[4:5], v7, s[36:37]
    v_add_u32 v7, 1, v0
    v_mul_u32_u24 v42, 21846, v7
    v_add_u32 v4, s59, v4
    v_and_b32 v5, 15, v4
    v_lshlrev_b32 v40, 7, v5
    v_mul_u32_u24 v41, 448, v5
    v_lshlrev_b32 v41, 10, v41
    v_lshrrev_b32 v42, 16, v42
    v_mul_u32_u24 v42, 3, v42
    v_sub_u32 v42, v7, v42
    v_mul_u32_u24 v42, 48, v42
    v_lshl_add_u32 v42, v42, 10, s30
    s_mov_b32 s35, 1
    v_readlane_b32 s32, v40, 1
    v_readlane_b32 s33, v41, 1
    s_add_u32 m0, s30, 98304
    s_and_b32 s38, s2, 3
    s_lshl_b32 s38, s38, 5
    s_lshr_b32 s39, s2, 3
    s_add_u32 s38, s38, s39
    s_lshl_b32 s38, s38, 2
    s_add_u32 s38, s38, s3
    s_mul_i32 s38, s38, 512
    s_mul_i32 s39, s41, 1572864
    s_add_u32 s39, s39, s38
    s_lshl_b32 s14, s41, 21
    s_sub_u32 s38, s38, s14
    s_add_u32 s38, s38, 4980736
    s_mov_b32 s93, 1
    s_mov_b32 s51, 0
    s_mov_b32 s98, 0
    s_mov_b32 s44, s84
    s_and_b32 s45, s85, 0xffff
    s_mov_b32 s46, 0
    s_mov_b32 s47, 0x20000
    s_mov_b32 s24, s6
    s_and_b32 s25, s7, 0xffff
    s_mov_b32 s26, 23265280
    s_mov_b32 s27, 0x20000
    s_branch LQnF
.p2align 6
LQF:
    s_waitcnt vmcnt(10)
    s_barrier
LQnF:
    buffer_load_dwordx4 v8, s[16:19], s32 offen offset:0 lds
    s_add_u32 s35, s35, 1
    s_buffer_load_dword s99, s[44:47], s38 offset:0
    s_buffer_load_dword s99, s[44:47], s38 offset:64
    buffer_load_dwordx4 v9, s[16:19], s32 offen offset:1024 lds
    v_readlane_b32 s94, v40, s35
    s_buffer_load_dword s99, s[44:47], s38 offset:128
    s_buffer_load_dword s99, s[44:47], s38 offset:192
    buffer_load_dwordx4 v10, s[16:19], s32 offen offset:2048 lds
    v_readlane_b32 s95, v41, s35
    s_buffer_load_dword s99, s[44:47], s38 offset:256
    s_buffer_load_dword s99, s[44:47], s38 offset:320
    buffer_load_dwordx4 v11, s[16:19], s32 offen offset:3072 lds
    s_buffer_load_dword s99, s[44:47], s38 offset:384
    s_buffer_load_dword s99, s[44:47], s38 offset:448
    s_add_u32 m0, m0, s31
    v_readlane_b32 s96, v42, s35
    buffer_load_dwordx4 v12, s[20:23], s33 offen offset:0 lds
    buffer_load_dwordx4 v13, s[20:23], s33 offen offset:1024 lds
    buffer_load_dwordx4 v14, s[20:23], s33 offen offset:2048 lds
    buffer_load_dwordx4 v15, s[20:23], s33 offen offset:3072 lds
    s_add_u32 m0, m0, 4096
    s_add_u32 s38, s38, 262144
    buffer_load_dwordx4 v16, s[20:23], s33 offen offset:0 lds
    buffer_load_dwordx4 v17, s[20:23], s33 offen offset:1024 lds
    s_mov_b64 s[32:33], s[94:95]
    s_mov_b32 m0, s96
    s_cmp_ge_u32 s35, 8
    s_cselect_b32 s46, 7340032, 0
    s_cmp_eq_u32 s35, 10
    s_cbranch_scc1 L_evF
L_evrF:
    s_cmp_lt_u32 s35, 16
    s_cbranch_scc1 LQF
    s_branch L_trF
L_restH:
    s_mov_b32 s36, 1750348304
    s_mov_b32 s37, 4275809431
    s_cmp_eq_u32 s40, 1
    s_cselect_b32 s36, 2522100240, s36
    s_cselect_b32 s37, 4274772615, s37
    s_cmp_eq_u32 s40, 2
    s_cselect_b32 s36, 1985229328, s36
    s_cselect_b32 s37, 4258183562, s37
    s_cmp_eq_u32 s40, 3
    s_cselect_b32 s36, 1702113808, s36
    s_cselect_b32 s37, 3992758712, s37
    v_lshlrev_b32 v7, 2, v0
    v_lshrrev_b64 v[4:5], v7, s[36:37]
    v_add_u32 v7, 1, v0
    v_mul_u32_u24 v42, 21846, v7
    v_add_u32 v4, s59, v4
    v_and_b32 v5, 15, v4
    v_lshlrev_b32 v40, 7, v5
    v_mul_u32_u24 v41, 448, v5
    v_lshlrev_b32 v41, 10, v41
    v_lshrrev_b32 v42, 16, v42
    v_mul_u32_u24 v42, 3, v42
    v_sub_u32 v42, v7, v42
    v_mul_u32_u24 v42, 48, v42
    v_lshl_add_u32 v42, v42, 10, s30
    s_mov_b32 s35, 1
    v_readlane_b32 s32, v40, 1
    v_readlane_b32 s33, v41, 1
    s_add_u32 m0, s30, 98304
    s_and_b32 s38, s2, 3
    s_lshl_b32 s38, s38, 5
    s_lshr_b32 s39, s2, 3
    s_add_u32 s38, s38, s39
    s_lshl_b32 s38, s38, 2
    s_add_u32 s38, s38, s3
    s_mul_i32 s38, s38, 512
    s_mul_i32 s39, s41, 1572864
    s_add_u32 s39, s39, s38
    s_lshl_b32 s14, s41, 21
    s_sub_u32 s38, s38, s14
    s_add_u32 s38, s38, 4980736
    s_mov_b32 s93, 1
    s_mov_b32 s51, 0
    s_mov_b32 s98, 0
    s_mov_b32 s44, s84
    s_and_b32 s45, s85, 0xffff
    s_mov_b32 s46, 0
    s_mov_b32 s47, 0x20000
    s_mov_b32 s24, s6
    s_and_b32 s25, s7, 0xffff
    s_mov_b32 s26, 23265280
    s_mov_b32 s27, 0x20000
    s_branch LQnH
.p2align 6
LQH:
    s_waitcnt vmcnt(12)
    s_barrier
LQnH:
    buffer_load_dwordx4 v8, s[16:19], s32 offen offset:0 lds
    s_add_u32 s35, s35, 1
    s_buffer_load_dword s99, s[44:47], s38 offset:0
    s_buffer_load_dword s99, s[44:47], s38 offset:64
    buffer_load_dwordx4 v9, s[16:19], s32 offen offset:1024 lds
    v_readlane_b32 s94, v40, s35
    s_buffer_load_dword s99, s[44:47], s38 offset:128
    s_buffer_load_dword s99, s[44:47], s38 offset:192
    buffer_load_dwordx4 v10, s[16:19], s32 offen offset:2048 lds
    v_readlane_b32 s95, v41, s35
    s_buffer_load_dword s99, s[44:47], s38 offset:256
    s_buffer_load_dword s99, s[44:47], s38 offset:320
    buffer_load_dwordx4 v11, s[16:19], s32 offen offset:3072 lds
    s_buffer_load_dword s99, s[44:47], s38 offset:384
    s_buffer_load_dword s99, s[44:47], s38 offset:448
    s_add_u32 m0, m0, s31
    v_readlane_b32 s96, v42, s35
    buffer_load_dwordx4 v12, s[20:23], s33 offen offset:0 lds
    buffer_load_dwordx4 v13, s[20:23], s33 offen offset:1024 lds
    buffer_load_dwordx4 v14, s[20:23], s33 offen offset:2048 lds
    buffer_load_dwordx4 v15, s[20:23], s33 offen offset:3072 lds
    s_add_u32 m0, m0, 4096
    s_add_u32 s38, s38, 262144
    buffer_load_dwordx4 v16, s[20:23], s33 offen offset:0 lds
    buffer_load_dwordx4 v17, s[20:23], s33 offen offset:1024 lds
    buffer_load_dwordx4 v18, s[20:23], s33 offen offset:2048 lds
    buffer_load_dwordx4 v19, s[20:23], s33 offen offset:3072 lds
    s_mov_b64 s[32:33], s[94:95]
    s_mov_b32 m0, s96
    s_cmp_ge_u32 s35, 8
    s_cselect_b32 s46, 7340032, 0
    s_cmp_eq_u32 s35, s97
    s_cbranch_scc1 L_evH
L_evrH:
    s_cmp_lt_u32 s35, 16
    s_cbranch_scc1 LQH
    s_branch L_trH
L_trF:
    s_setprio 0
    s_add_u32 s29, s15, s30
    v_lshl_add_u32 v8, v0, 4, s29
    v_and_b32 v1, 15, v0
    v_lshlrev_b32 v2, 1, v3
    v_xor_b32 v4, v1, v2
    v_lshlrev_b32 v1, 11, v3
    v_lshl_add_u32 v1, v4, 4, v1
    s_lshr_b32 s28, s3, 1
    s_lshl_b32 s28, s28, 16
    s_and_b32 s29, s3, 1
    s_lshl_b32 s29, s29, 14
    s_add_u32 s28, s28, s29
    s_lshl_b32 s29, s11, 8
    s_add_u32 s28, s28, s29
    v_add_u32 v12, s28, v1
    v_add_u32 v13, 31744, v12
    v_xor_b32 v14, 128, v12
    v_add_u32 v14, 6144, v14
    v_add_u32 v15, 31744, v14
    v_lshlrev_b32 v40, 14, v46
    v_lshlrev_b32 v41, 17, v46
    v_add_u32 v7, 3, v0
    v_mul_u32_u24 v42, 13108, v7
    v_lshrrev_b32 v42, 16, v42
    v_mul_u32_u24 v42, 5, v42
    v_sub_u32 v42, v7, v42
    v_lshl_add_u32 v42, v42, 15, s30
    s_mov_b64 s[16:17], s[24:25]
    s_mov_b32 s18, s26
    s_mov_b64 s[20:21], s[44:45]
    v_readlane_b32 s80, v41, 0
    v_readlane_b32 s81, v41, 1
    v_readlane_b32 s82, v41, 2
    v_readlane_b32 s83, v41, 3
    v_readlane_b32 s84, v41, 4
    v_readlane_b32 s85, v41, 5
    v_readlane_b32 s88, v40, 3
    v_readlane_b32 s89, v40, 4
    v_readlane_b32 s90, v40, 5
    v_readlane_b32 s32, v40, 6
    v_readlane_b32 s33, v41, 6
    s_lshl_b32 s52, s41, 7
    s_add_u32 s52, s52, s48
    s_movk_i32 s53, 272
    s_mov_b32 s50, 1
    s_waitcnt vmcnt(10)
    s_barrier
    s_add_u32 m0, s30, 114688
    s_nop 0
    buffer_load_dwordx4 v12, s[20:23], s80 offen offset:0 lds
    buffer_load_dwordx4 v13, s[20:23], s80 offen offset:1024 lds
    buffer_load_dwordx4 v14, s[20:23], s80 offen offset:2048 lds
    buffer_load_dwordx4 v15, s[20:23], s80 offen offset:3072 lds
    s_add_u32 m0, s30, 147456
    s_nop 0
    buffer_load_dwordx4 v12, s[20:23], s81 offen offset:0 lds
    buffer_load_dwordx4 v13, s[20:23], s81 offen offset:1024 lds
    buffer_load_dwordx4 v14, s[20:23], s81 offen offset:2048 lds
    buffer_load_dwordx4 v15, s[20:23], s81 offen offset:3072 lds
    s_cmp_eq_u32 s3, 0
    s_cbranch_scc0 L_iokF
L_icF:
    s_cmp_eq_u32 s51, 1
    s_cbranch_scc1 L_iokF
    s_waitcnt lgkmcnt(0)
    s_cmp_eq_u32 s51, 1
    s_cbranch_scc1 L_iokF
    s_mov_b32 s51, 0
    s_atomic_add s51, s[4:5], s49 glc
    s_branch L_icF
L_iokF:
    s_waitcnt vmcnt(8)
    s_barrier
    s_add_u32 m0, s30, 16384
    s_nop 0
    buffer_load_dwordx4 v12, s[20:23], s82 offen offset:0 lds
    buffer_load_dwordx4 v13, s[20:23], s82 offen offset:1024 lds
    buffer_load_dwordx4 v14, s[20:23], s82 offen offset:2048 lds
    buffer_load_dwordx4 v15, s[20:23], s82 offen offset:3072 lds
    s_barrier
    s_add_u32 m0, s30, 49152
    s_nop 0
    buffer_load_dwordx4 v12, s[20:23], s83 offen offset:0 lds
    buffer_load_dwordx4 v13, s[20:23], s83 offen offset:1024 lds
    buffer_load_dwordx4 v14, s[20:23], s83 offen offset:2048 lds
    buffer_load_dwordx4 v15, s[20:23], s83 offen offset:3072 lds
    s_add_u32 m0, s30, 81920
    s_nop 0
    buffer_load_dwordx4 v12, s[20:23], s84 offen offset:0 lds
    buffer_load_dwordx4 v13, s[20:23], s84 offen offset:1024 lds
    buffer_load_dwordx4 v14, s[20:23], s84 offen offset:2048 lds
    buffer_load_dwordx4 v15, s[20:23], s84 offen offset:3072 lds
    s_waitcnt vmcnt(8)
    s_barrier
    s_barrier
    s_add_u32 m0, s30, 114688
    s_nop 0
    buffer_load_dwordx4 v12, s[20:23], s85 offen offset:0 lds
    buffer_load_dwordx4 v13, s[20:23], s85 offen offset:1024 lds
    buffer_load_dwordx4 v14, s[20:23], s85 offen offset:2048 lds
    buffer_load_dwordx4 v15, s[20:23], s85 offen offset:3072 lds
    s_cmp_eq_u32 s3, 0
    s_cbranch_scc0 L_gokF
L_gF:
    s_waitcnt lgkmcnt(0)
    s_cmp_eq_u32 s50, s53
    s_cbranch_scc1 L_gokF
    s_mov_b32 s50, 0
    s_atomic_add s50, s[6:7], s52 glc
    s_branch L_gF
L_gokF:
    s_barrier
    s_add_u32 m0, s30, 32768
    s_nop 0
    buffer_load_dwordx4 v8, s[16:19], s88 offen offset:0 sc1 lds
    buffer_load_dwordx4 v8, s[16:19], s88 offen offset:1024 sc1 lds
    buffer_load_dwordx4 v8, s[16:19], s88 offen offset:2048 sc1 lds
    buffer_load_dwordx4 v8, s[16:19], s88 offen offset:3072 sc1 lds
    s_add_u32 m0, s30, 65536
    s_nop 0
    buffer_load_dwordx4 v8, s[16:19], s89 offen offset:0 sc1 lds
    buffer_load_dwordx4 v8, s[16:19], s89 offen offset:1024 sc1 lds
    buffer_load_dwordx4 v8, s[16:19], s89 offen offset:2048 sc1 lds
    buffer_load_dwordx4 v8, s[16:19], s89 offen offset:3072 sc1 lds
    s_add_u32 m0, s30, 98304
    s_nop 0
    buffer_load_dwordx4 v8, s[16:19], s90 offen offset:0 sc1 lds
    buffer_load_dwordx4 v8, s[16:19], s90 offen offset:1024 sc1 lds
    buffer_load_dwordx4 v8, s[16:19], s90 offen offset:2048 sc1 lds
    buffer_load_dwordx4 v8, s[16:19], s90 offen offset:3072 sc1 lds
    s_xor_b32 s58, s52, 128
    s_mov_b32 s59, s52
    s_add_u32 s52, s58, 0
    s_movk_i32 s53, 272
    s_mov_b32 s54, 6
    s_mov_b32 s55, 11
    s_add_u32 s80, s59, 256
    s_movk_i32 s81, 272
    s_mov_b32 s82, 11
    s_mov_b32 s83, 16
    s_mov_b64 s[84:85], -1
    s_mov_b64 s[86:87], -1
    s_mov_b32 s42, 33
    s_and_b32 s38, s2, 3
    s_lshl_b32 s38, s38, 4
    s_bfe_u32 s39, s2, 0x40003
    s_add_u32 s38, s38, s39
    s_lshl_b32 s38, s38, 2
    s_add_u32 s38, s38, s3
    s_mul_i32 s38, s38, 256
    s_lshl_b32 s39, s41, 21
    s_sub_u32 s39, 5242880, s39
    s_add_u32 s38, s38, s39
    s_add_u32 s46, s39, 1572864
    s_mov_b32 s56, 0
    s_mov_b32 s35, 6
    s_add_u32 m0, s30, 131072
    s_waitcnt vmcnt(8)
    s_branch L_p2
L_evF:
    s_getpc_b64 s[42:43]
L_pc2F:
    s_lshl_b32 s29, s10, 3
    s_add_u32 s29, s29, s11
    s_lshl_b32 s29, s29, 2
    s_add_u32 s29, s29, s40
    s_lshl_b32 s29, s29, 6
    s_add_u32 s29, s29, L_tab-L_pc2F
    v_add_u32 v6, s29, v0
    global_load_ubyte v46, v6, s[42:43]
    s_mov_b32 s38, s39
    s_cmp_eq_u32 s3, 0
    s_cbranch_scc0 L_evrF
    s_atomic_add s51, s[4:5], s49 glc
    s_branch L_evrF
L_evH:
    s_cmp_eq_u32 s35, 10
    s_cbranch_scc1 L_ev10
    s_load_dword s99, s[84:85], s34 offset:0
    s_load_dword s99, s[84:85], s34 offset:64
    s_load_dword s99, s[84:85], s34 offset:128
    s_load_dword s99, s[84:85], s34 offset:192
    s_load_dword s99, s[84:85], s34 offset:2048
    s_load_dword s99, s[84:85], s34 offset:2112
    s_load_dword s99, s[84:85], s34 offset:2176
    s_load_dword s99, s[84:85], s34 offset:2240
    s_add_u32 s34, s34, 4096
    s_cmp_eq_u32 s35, 6
    s_cselect_b32 s97, 7, 10
    s_branch L_evrH
L_ev10:
    s_getpc_b64 s[42:43]
L_pc2H:
    s_lshl_b32 s29, s10, 3
    s_add_u32 s29, s29, s11
    s_lshl_b32 s29, s29, 2
    s_add_u32 s29, s29, s40
    s_lshl_b32 s29, s29, 6
    s_add_u32 s29, s29, L_tab-L_pc2H
    v_add_u32 v6, s29, v0
    global_load_ubyte v46, v6, s[42:43]
    s_mov_b32 s38, s39
    s_cmp_eq_u32 s3, 0
    s_cbranch_scc0 L_evrH
    s_atomic_add s51, s[4:5], s49 glc
    s_branch L_evrH
L_trH:
    s_setprio 0
    s_add_u32 s29, s15, s30
    v_lshl_add_u32 v8, v0, 4, s29
    v_and_b32 v1, 15, v0
    v_lshlrev_b32 v2, 1, v3
    v_xor_b32 v4, v1, v2
    v_lshlrev_b32 v1, 11, v3
    v_lshl_add_u32 v1, v4, 4, v1
    s_lshr_b32 s28, s3, 1
    s_lshl_b32 s28, s28, 16
    s_and_b32 s29, s3, 1
    s_lshl_b32 s29, s29, 14
    s_add_u32 s28, s28, s29
    s_lshl_b32 s29, s11, 8
    s_add_u32 s28, s28, s29
    v_add_u32 v12, s28, v1
    v_add_u32 v13, 31744, v12
    v_xor_b32 v14, 128, v12
    v_add_u32 v14, 6144, v14
    v_add_u32 v15, 31744, v14
    v_lshlrev_b32 v40, 14, v46
    v_lshlrev_b32 v41, 17, v46
    v_add_u32 v7, 3, v0
    v_mul_u32_u24 v42, 13108, v7
    v_lshrrev_b32 v42, 16, v42
    v_mul_u32_u24 v42, 5, v42
    v_sub_u32 v42, v7, v42
    v_lshl_add_u32 v42, v42, 15, s30
    s_mov_b64 s[16:17], s[24:25]
    s_mov_b32 s18, s26
    s_mov_b64 s[20:21], s[44:45]
    v_readlane_b32 s36, v40, 0
    v_readlane_b32 s37, v40, 1
    v_readlane_b32 s39, v40, 2
    v_readlane_b32 s57, v40, 3
    v_lshl_add_u32 v47, v0, 4, s30
    v_add_u32 v48, 98304, v47
    v_readlane_b32 s80, v41, 0
    v_readlane_b32 s81, v41, 1
    v_readlane_b32 s82, v41, 2
    v_readlane_b32 s83, v41, 3
    v_readlane_b32 s84, v41, 4
    v_readlane_b32 s85, v41, 5
    v_readlane_b32 s89, v40, 4
    v_readlane_b32 s90, v40, 5
    v_readlane_b32 s32, v40, 6
    v_readlane_b32 s33, v41, 6
    s_lshl_b32 s52, s41, 7
    s_add_u32 s52, s52, s48
    s_movk_i32 s53, 272
    s_mov_b32 s50, 1
    s_waitcnt vmcnt(12)
    s_barrier
    s_add_u32 m0, s30, 114688
    s_nop 0
    buffer_load_dwordx4 v12, s[20:23], s80 offen offset:0 lds
    buffer_load_dwordx4 v13, s[20:23], s80 offen offset:1024 lds
    buffer_load_dwordx4 v14, s[20:23], s80 offen offset:2048 lds
    buffer_load_dwordx4 v15, s[20:23], s80 offen offset:3072 lds
    s_add_u32 m0, s30, 147456
    s_nop 0
    buffer_load_dwordx4 v12, s[20:23], s81 offen offset:0 lds
    buffer_load_dwordx4 v13, s[20:23], s81 offen offset:1024 lds
    buffer_load_dwordx4 v14, s[20:23], s81 offen offset:2048 lds
    buffer_load_dwordx4 v15, s[20:23], s81 offen offset:3072 lds
    s_cmp_eq_u32 s3, 0
    s_cbranch_scc0 L_iokH
L_icH:
    s_cmp_eq_u32 s51, 1
    s_cbranch_scc1 L_iokH
    s_waitcnt lgkmcnt(0)
    s_cmp_eq_u32 s51, 1
    s_cbranch_scc1 L_iokH
    s_mov_b32 s51, 0
    s_atomic_add s51, s[4:5], s49 glc
    s_branch L_icH
L_iokH:
    s_waitcnt vmcnt(8)
    s_barrier
    s_add_u32 m0, s30, 16384
    s_nop 0
    buffer_load_dwordx4 v12, s[20:23], s82 offen offset:0 lds
    buffer_load_dwordx4 v13, s[20:23], s82 offen offset:1024 lds
    buffer_load_dwordx4 v14, s[20:23], s82 offen offset:2048 lds
    buffer_load_dwordx4 v15, s[20:23], s82 offen offset:3072 lds
    s_barrier
    s_add_u32 m0, s30, 49152
    s_nop 0
    buffer_load_dwordx4 v12, s[20:23], s83 offen offset:0 lds
    buffer_load_dwordx4 v13, s[20:23], s83 offen offset:1024 lds
    buffer_load_dwordx4 v14, s[20:23], s83 offen offset:2048 lds
    buffer_load_dwordx4 v15, s[20:23], s83 offen offset:3072 lds
    s_add_u32 m0, s30, 81920
    s_nop 0
    buffer_load_dwordx4 v12, s[20:23], s84 offen offset:0 lds
    buffer_load_dwordx4 v13, s[20:23], s84 offen offset:1024 lds
    buffer_load_dwordx4 v14, s[20:23], s84 offen offset:2048 lds
    buffer_load_dwordx4 v15, s[20:23], s84 offen offset:3072 lds
    s_waitcnt vmcnt(8)
    s_barrier
    ds_read_b128 v[80:83], v48 offset:32768
    ds_read_b128 v[84:87], v48 offset:33792
    ds_read_b128 v[88:91], v48 offset:34816
    ds_read_b128 v[92:95], v48 offset:35840
    ds_read_b128 v[112:115], v47 offset:32768
    ds_read_b128 v[116:119], v47 offset:33792
    ds_read_b128 v[120:123], v47 offset:34816
    ds_read_b128 v[124:127], v47 offset:35840
    s_add_u32 s92, s52, 256
    s_waitcnt lgkmcnt(0)
    s_mov_b32 s50, 0
    s_atomic_add s50, s[6:7], s52 glc
L_npa:
    buffer_store_dwordx4 v[80:83], v8, s[16:19], s37 offen offset:0 sc1
    buffer_store_dwordx4 v[84:87], v8, s[16:19], s37 offen offset:1024 sc1
    buffer_store_dwordx4 v[88:91], v8, s[16:19], s37 offen offset:2048 sc1
    buffer_store_dwordx4 v[92:95], v8, s[16:19], s37 offen offset:3072 sc1
    s_barrier
    buffer_store_dwordx4 v[112:115], v8, s[16:19], s57 offen offset:0 sc1
    buffer_store_dwordx4 v[116:119], v8, s[16:19], s57 offen offset:1024 sc1
    buffer_store_dwordx4 v[120:123], v8, s[16:19], s57 offen offset:2048 sc1
    buffer_store_dwordx4 v[124:127], v8, s[16:19], s57 offen offset:3072 sc1
L_gH:
    s_waitcnt lgkmcnt(0)
    s_cmp_eq_u32 s50, s53
    s_cbranch_scc1 L_gokH
    s_mov_b32 s50, 0
    s_atomic_add s50, s[6:7], s52 glc
    s_branch L_gH
L_gokH:
    s_add_u32 m0, s30, 65536
    s_nop 0
    buffer_load_dwordx4 v8, s[16:19], s89 offen offset:0 sc1 lds
    buffer_load_dwordx4 v8, s[16:19], s89 offen offset:1024 sc1 lds
    buffer_load_dwordx4 v8, s[16:19], s89 offen offset:2048 sc1 lds
    buffer_load_dwordx4 v8, s[16:19], s89 offen offset:3072 sc1 lds
    s_barrier
    s_add_u32 m0, s30, 114688
    s_nop 0
    buffer_load_dwordx4 v12, s[20:23], s85 offen offset:0 lds
    buffer_load_dwordx4 v13, s[20:23], s85 offen offset:1024 lds
    buffer_load_dwordx4 v14, s[20:23], s85 offen offset:2048 lds
    buffer_load_dwordx4 v15, s[20:23], s85 offen offset:3072 lds
    s_add_u32 m0, s30, 98304
    s_nop 0
    buffer_load_dwordx4 v8, s[16:19], s90 offen offset:0 sc1 lds
    buffer_load_dwordx4 v8, s[16:19], s90 offen offset:1024 sc1 lds
    buffer_load_dwordx4 v8, s[16:19], s90 offen offset:2048 sc1 lds
    buffer_load_dwordx4 v8, s[16:19], s90 offen offset:3072 sc1 lds
    s_add_u32 m0, s30, 131072
    s_waitcnt vmcnt(12)
    s_atomic_add s93, s[6:7], s92
    s_barrier
    buffer_load_dwordx4 v8, s[16:19], s32 offen offset:0 sc1 lds
    v_readlane_b32 s94, v40, 7
    buffer_load_dwordx4 v8, s[16:19], s32 offen offset:1024 sc1 lds
    v_readlane_b32 s95, v41, 7
    buffer_load_dwordx4 v8, s[16:19], s32 offen offset:2048 sc1 lds
    buffer_load_dwordx4 v8, s[16:19], s32 offen offset:3072 sc1 lds
    s_add_u32 m0, m0, 16384
    s_nop 0
    buffer_load_dwordx4 v12, s[20:23], s33 offen offset:0 lds
    buffer_load_dwordx4 v13, s[20:23], s33 offen offset:1024 lds
    buffer_load_dwordx4 v14, s[20:23], s33 offen offset:2048 lds
    buffer_load_dwordx4 v15, s[20:23], s33 offen offset:3072 lds
    s_mov_b64 s[32:33], s[94:95]
    s_add_u32 m0, s30, 0
    s_waitcnt vmcnt(16)
    s_barrier
    buffer_load_dwordx4 v8, s[16:19], s32 offen offset:0 sc1 lds
    v_readlane_b32 s94, v40, 8
    buffer_load_dwordx4 v8, s[16:19], s32 offen offset:1024 sc1 lds
    v_readlane_b32 s95, v41, 8
    buffer_load_dwordx4 v8, s[16:19], s32 offen offset:2048 sc1 lds
    buffer_load_dwordx4 v8, s[16:19], s32 offen offset:3072 sc1 lds
    s_add_u32 m0, m0, 16384
    s_nop 0
    buffer_load_dwordx4 v12, s[20:23], s33 offen offset:0 lds
    buffer_load_dwordx4 v13, s[20:23], s33 offen offset:1024 lds
    buffer_load_dwordx4 v14, s[20:23], s33 offen offset:2048 lds
    buffer_load_dwordx4 v15, s[20:23], s33 offen offset:3072 lds
    s_mov_b64 s[32:33], s[94:95]
    s_add_u32 m0, s30, 32768
    s_waitcnt vmcnt(16)
    s_xor_b32 s58, s52, 128
    s_mov_b32 s59, s52
    s_add_u32 s52, s59, 256
    s_movk_i32 s53, 272
    s_mov_b32 s54, 8
    s_mov_b32 s55, 10
    s_mov_b64 s[80:81], -1
    s_mov_b64 s[82:83], -1
    s_mov_b64 s[84:85], -1
    s_mov_b64 s[86:87], -1
    s_mov_b32 s42, 23
    s_mov_b32 s46, 0
    s_mov_b32 s56, s42
    s_mov_b32 s35, 8
    s_add_u32 m0, s30, 32768
L_p2:
    s_mov_b32 s50, 1
    s_cmp_eq_u32 s3, 0
    s_cselect_b32 s54, s54, -1
    s_branch LP_bar
.p2align 6
LP:
    s_waitcnt vmcnt(16)
LP_bar:
    s_barrier
LP_nb:
    buffer_load_dwordx4 v8, s[16:19], s32 offen offset:0 sc1 lds
    s_buffer_load_dword s99, s[44:47], s38 offset:0
    s_cmp_eq_u32 s35, s54
    s_cbranch_scc1 L_pv
L_pvret:
    s_add_u32 s35, s35, 1
    buffer_load_dwordx4 v8, s[16:19], s32 offen offset:1024 sc1 lds
    s_buffer_load_dword s99, s[44:47], s38 offset:64
    v_readlane_b32 s94, v40, s35
    buffer_load_dwordx4 v8, s[16:19], s32 offen offset:2048 sc1 lds
    s_buffer_load_dword s99, s[44:47], s38 offset:128
    v_readlane_b32 s95, v41, s35
    buffer_load_dwordx4 v8, s[16:19], s32 offen offset:3072 sc1 lds
    s_buffer_load_dword s99, s[44:47], s38 offset:192
    s_add_u32 m0, m0, 16384
    v_readlane_b32 s96, v42, s35
    s_add_u32 s39, s38, 65536
    buffer_load_dwordx4 v12, s[20:23], s33 offen offset:0 lds
    buffer_load_dwordx4 v13, s[20:23], s33 offen offset:1024 lds
    buffer_load_dwordx4 v14, s[20:23], s33 offen offset:2048 lds
    s_cmp_lt_u32 s35, s56
    buffer_load_dwordx4 v15, s[20:23], s33 offen offset:3072 lds
    s_mov_b64 s[32:33], s[94:95]
    s_mov_b32 m0, s96
    s_mov_b32 s38, s39
    s_cbranch_scc1 LP
    s_cmp_eq_u32 s35, 7
    s_cbranch_scc0 L_pdone
    s_mov_b32 s56, s42
    s_waitcnt vmcnt(12)
    s_branch LP_bar
L_pv:
    s_cmp_eq_u32 s50, s53
    s_cbranch_scc1 L_gok
    s_cmp_eq_u32 s35, s55
    s_cbranch_scc1 L_gate
    s_add_u32 s54, s35, 1
    s_cmp_eq_u32 s50, 0
    s_cbranch_scc1 L_pvret
    s_mov_b32 s50, 0
    s_atomic_add s50, s[6:7], s52 glc
    s_branch L_pvret
L_gate:
    s_waitcnt lgkmcnt(0)
    s_cmp_eq_u32 s50, s53
    s_cbranch_scc1 L_gok
    s_mov_b32 s50, 0
    s_atomic_add s50, s[6:7], s52 glc
    s_branch L_gate
L_gok:
    s_mov_b32 s50, 1
    s_mov_b64 s[52:53], s[80:81]
    s_mov_b64 s[54:55], s[82:83]
    s_mov_b64 s[80:81], s[84:85]
    s_mov_b64 s[82:83], s[86:87]
    s_mov_b64 s[84:85], -1
    s_mov_b64 s[86:87], -1
    s_add_u32 s94, s35, 1
    s_max_u32 s54, s54, s94
    s_branch L_pvret
L_pdone:
    s_cmp_eq_u32 s10, 1
    s_cbranch_scc1 L_ptail
    s_mul_i32 s28, s13, 532480
    s_mul_i32 s29, s11, 66560
    s_add_u32 s28, s28, s29
    s_sub_u32 s32, s28, s15
    s_add_u32 s32, s32, 14745600
    s_lshl_b32 s52, s11, 7
    s_add_u32 s52, s52, s48
    s_add_u32 s52, s52, 512
    s_mov_b32 s50, 0
    s_atomic_add s50, s[6:7], s52 glc
    s_mov_b32 s59, 0
    s_mov_b32 s58, 0
    s_mov_b32 s35, 0
    s_waitcnt vmcnt(16)
    s_barrier
    s_waitcnt vmcnt(0)
LT:
    s_cmp_eq_u32 s59, 0
    s_cbranch_scc0 LT_n0
    s_and_b32 s28, s50, 15
    s_cmp_eq_u32 s28, 4
    s_cbranch_scc0 LT_poll
    s_add_u32 m0, s30, 32768
    s_add_u32 s59, s59, 1
    buffer_load_dwordx4 v8, s[16:19], s32 offen offset:0 sc1 lds
    buffer_load_dwordx4 v8, s[16:19], s32 offen offset:1024 sc1 lds
    buffer_load_dwordx4 v8, s[16:19], s32 offen offset:2048 sc1 lds
    buffer_load_dwordx4 v8, s[16:19], s32 offen offset:3072 sc1 lds
    s_add_u32 m0, m0, 16384
    s_add_u32 s32, s32, 16384
    buffer_load_dwordx4 v8, s[16:19], s32 offen offset:0 sc1 lds
    buffer_load_dwordx4 v8, s[16:19], s32 offen offset:1024 sc1 lds
    buffer_load_dwordx4 v8, s[16:19], s32 offen offset:2048 sc1 lds
    buffer_load_dwordx4 v8, s[16:19], s32 offen offset:3072 sc1 lds
    s_add_u32 m0, m0, 16384
    s_add_u32 s32, s32, 16384
LT_n0:
    s_cmp_eq_u32 s59, 1
    s_cbranch_scc0 LT_n1
    s_cmpk_eq_u32 s50, 324
    s_cbranch_scc0 LT_poll
    s_add_u32 m0, s30, 65536
    s_add_u32 s59, s59, 1
    buffer_load_dwordx4 v8, s[16:19], s32 offen offset:0 sc1 lds
    buffer_load_dwordx4 v8, s[16:19], s32 offen offset:1024 sc1 lds
    buffer_load_dwordx4 v8, s[16:19], s32 offen offset:2048 sc1 lds
    buffer_load_dwordx4 v8, s[16:19], s32 offen offset:3072 sc1 lds
    s_add_u32 m0, m0, 16384
    s_add_u32 s32, s32, 16384
    buffer_load_dwordx4 v8, s[16:19], s32 offen offset:0 sc1 lds
    buffer_load_dwordx4 v8, s[16:19], s32 offen offset:1024 sc1 lds
    buffer_load_dwordx4 v8, s[16:19], s32 offen offset:2048 sc1 lds
    buffer_load_dwordx4 v8, s[16:19], s32 offen offset:3072 sc1 lds
    s_add_u32 m0, m0, 16384
    s_add_u32 s32, s32, 16384
LT_n1:
    s_branch LT_go
LT_poll:
    s_cmp_eq_u32 s50, 0
    s_cbranch_scc1 LT_go
    s_mov_b32 s50, 0
    s_atomic_add s50, s[6:7], s52 glc
LT_go:
    s_cmp_lt_u32 s35, 3
    s_cbranch_scc1 LT_bar
    s_cmp_eq_u32 s59, 2
    s_cbranch_scc1 LT_both
    s_cmp_eq_u32 s35, 3
    s_cselect_b32 s28, s58, 0
    s_mov_b32 s58, s59
    s_cmp_eq_u32 s28, 1
    s_cbranch_scc1 LT_one
    s_waitcnt lgkmcnt(0)
    s_branch LT
LT_one:
    s_waitcnt vmcnt(0)
LT_bar:
    s_add_u32 s35, s35, 1
    s_barrier
    s_branch LT
LT_both:
    s_cmp_eq_u32 s35, 3
    s_cbranch_scc0 LT_last
    s_waitcnt vmcnt(8)
    s_barrier
LT_last:
    s_waitcnt vmcnt(0)
    s_barrier
    s_branch L_pend
L_ptail:
    s_waitcnt vmcnt(16)
    s_barrier
    s_waitcnt vmcnt(8)
    s_barrier
    s_waitcnt vmcnt(0)
    s_barrier
    s_barrier
L_pend:
L_end:
    s_endpgm
L_cons:
    s_getpc_b64 s[42:43]
L_pc1:
    s_sub_u32 s42, s42, L_pc1-standalone__dense_activation_relu__prompt_kernel
    s_subb_u32 s43, s43, 0
    s_lshr_b32 s30, s2, 3
    s_lshl_b32 s30, s30, 2
    s_add_u32 s30, s30, s12
    s_lshl_b32 s30, s30, 6
    s_min_u32 s31, s30, L_tabend-standalone__dense_activation_relu__prompt_kernel-4
    s_load_dword s101, s[42:43], s31
    s_add_u32 s30, s30, 8192
    s_min_u32 s31, s30, L_tabend-standalone__dense_activation_relu__prompt_kernel-4
    s_load_dword s101, s[42:43], s31
    s_add_u32 s30, s30, 8192
    s_min_u32 s31, s30, L_tabend-standalone__dense_activation_relu__prompt_kernel-4
    s_load_dword s101, s[42:43], s31
    s_add_u32 s30, s30, 8192
    v_mov_b32 v240, v0
    v_mov_b32 v128, 0
    v_mov_b32 v129, 0
    v_mov_b32 v130, 0
    v_mov_b32 v131, 0
    s_or_b32 s30, s10, s11
    s_or_b32 s30, s30, s12
    s_cmp_eq_u32 s30, 0
    s_cselect_b32 s50, 1, 0
    s_cbranch_scc0 L_noinit
    s_waitcnt lgkmcnt(0)
    s_movk_i32 s88, 256
    s_atomic_swap s88, s[6:7], s48 offset:0 glc
    s_movk_i32 s89, 256
    s_atomic_swap s89, s[6:7], s48 offset:128 glc
    s_movk_i32 s90, 256
    s_atomic_swap s90, s[6:7], s48 offset:256 glc
    s_movk_i32 s91, 256
    s_atomic_swap s91, s[6:7], s48 offset:384 glc
    s_movk_i32 s92, 256
    s_atomic_swap s92, s[6:7], s48 offset:512 glc
    s_movk_i32 s93, 256
    s_atomic_swap s93, s[6:7], s48 offset:640 glc
    s_movk_i32 s94, 256
    s_atomic_swap s94, s[6:7], s48 offset:768 glc
    s_movk_i32 s95, 256
    s_atomic_swap s95, s[6:7], s48 offset:896 glc
    s_movk_i32 s96, 256
    s_atomic_swap s96, s[6:7], s48 offset:1024 glc
    s_movk_i32 s97, 256
    s_atomic_swap s97, s[6:7], s48 offset:1152 glc
    s_movk_i32 s98, 256
    s_atomic_swap s98, s[6:7], s48 offset:1280 glc
    s_movk_i32 s99, 256
    s_atomic_swap s99, s[6:7], s48 offset:1408 glc
L_noinit:
    v_mfma_f32_32x32x16_bf16 v[0:15], v[128:131], v[128:131], 0
    s_and_b32 s28, s12, 1
    s_lshr_b32 s29, s12, 1
    v_and_b32 v245, 15, v240
    v_lshrrev_b32 v246, 4, v240
    v_lshrrev_b32 v247, 1, v245
    v_mfma_f32_32x32x16_bf16 v[16:31], v[128:131], v[128:131], 0
    v_xor_b32 v247, v246, v247
    v_lshlrev_b32 v247, 4, v247
    v_lshl_add_u32 v247, v245, 7, v247
    s_lshl_b32 s30, s28, 13
    s_add_u32 s31, s30, 49152
    v_mfma_f32_32x32x16_bf16 v[32:47], v[128:131], v[128:131], 0
    v_add_u32 v224, s31, v247
    v_xor_b32 v225, 64, v224
    v_lshl_add_u32 v253, v240, 4, s30
    v_add_u32 v254, 4096, v253
    v_add_u32 v234, 98304, v253
    v_mfma_f32_32x32x16_bf16 v[48:63], v[128:131], v[128:131], 0
    v_add_u32 v235, 1024, v234
    s_lshl_b32 s30, s12, 13
    v_lshl_add_u32 v241, v240, 4, s30
    v_lshrrev_b32 v247, 2, v240
    v_and_b32 v247, 3, v247
    v_mfma_f32_32x32x16_bf16 v[64:79], v[128:131], v[128:131], 0
    v_lshl_add_u32 v248, v246, 3, v247
    v_and_b32 v249, 3, v240
    v_lshlrev_b32 v249, 3, v249
    v_add_u32 v249, 65536, v249
    v_and_b32 v250, 1, v246
    v_mfma_f32_32x32x16_bf16 v[80:95], v[128:131], v[128:131], 0
    v_lshl_or_b32 v251, v250, 2, v247
    s_lshl_b32 s30, s29, 2
    v_xor_b32 v252, s30, v251
    v_lshl_add_u32 v236, v248, 8, v249
    v_lshl_add_u32 v236, v252, 5, v236
    v_mfma_f32_32x32x16_bf16 v[96:111], v[128:131], v[128:131], 0
    v_add_u32 v236, 49152, v236
    v_xor_b32 v237, 32, v236
    v_xor_b32 v238, 64, v236
    v_xor_b32 v239, 96, v236
    v_mov_b32 v244, 1
    v_mfma_f32_32x32x16_bf16 v[112:127], v[128:131], v[128:131], 0
    s_lshl_b32 s30, s13, 18
    s_lshl_b32 s31, s28, 17
    s_add_u32 s43, s30, s31
    s_lshl_b32 s30, s11, 8
    s_lshl_b32 s31, s29, 7
    s_add_u32 s30, s30, s31
    s_add_u32 s43, s43, s30
    v_mov_b32 v242, s43
    s_mov_b32 s32, 49152
    s_mov_b32 s33, 4294868992
    s_mov_b32 s34, 1
    s_mov_b32 s35, 15
    s_mov_b32 s26, 23265280
    s_mov_b32 s27, 0x20000
    s_mov_b32 s22, 4194304
    s_mov_b32 s23, 0x20000
    s_cmp_eq_u32 s10, 1
    s_cbranch_scc1 L_g1H
    v_lshrrev_b32 v252, 1, v247
    v_lshl_or_b32 v252, v250, 1, v252
    v_mul_u32_u24 v245, 384, v248
    v_add_u32 v245, v245, v249
    s_mul_i32 s30, s29, 6
    v_xor_b32 v226, s30, v252
    v_lshl_add_u32 v226, v226, 5, v245
    s_add_u32 s30, s30, 1
    v_xor_b32 v227, s30, v252
    v_lshl_add_u32 v227, v227, 5, v245
    s_add_u32 s30, s30, 1
    v_xor_b32 v228, s30, v252
    v_lshl_add_u32 v228, v228, 5, v245
    s_add_u32 s30, s30, 1
    v_xor_b32 v229, s30, v252
    v_lshl_add_u32 v229, v229, 5, v245
    s_add_u32 s30, s30, 1
    v_xor_b32 v230, s30, v252
    v_lshl_add_u32 v230, v230, 5, v245
    s_add_u32 s30, s30, 1
    v_xor_b32 v231, s30, v252
    v_lshl_add_u32 v231, v231, 5, v245
    s_add_u32 s30, s30, 1
    s_mul_i32 s37, s11, 49152
    s_lshl_b32 s30, s41, 7
    s_add_u32 s30, s30, s48
    v_mov_b32 v243, s30
    s_add_u32 s37, s37, s15
    s_cmp_eq_u32 s29, 0
    s_mov_b32 s30, 132096
    s_cselect_b32 s30, 98304, s30
    v_add_u32 v245, s30, v253
    s_mov_b32 s44, 17408
    s_cselect_b32 s44, 0, s44
    s_mov_b32 s30, 0
    s_cselect_b32 s30, 99328, s30
    v_add_u32 v246, s30, v253
    s_mov_b32 s45, 32768
    s_cselect_b32 s45, 1024, s45
    s_mov_b32 s30, 1024
    s_cselect_b32 s30, 131072, s30
    v_add_u32 v247, s30, v253
    s_mov_b32 s46, 33792
    s_cselect_b32 s46, 16384, s46
    s_add_u32 s44, s44, s37
    s_add_u32 s45, s45, s37
    s_add_u32 s46, s46, s37
    s_waitcnt lgkmcnt(0)
    s_mov_b32 s8, s6
    s_mov_b32 s9, s7
    s_mov_b32 s24, s6
    s_and_b32 s25, s7, 0xffff
    s_mov_b32 s20, s86
    s_and_b32 s21, s87, 0xffff
    s_cmp_eq_u32 s50, 1
    s_cbranch_scc0 L_noinit2
    s_atomic_add s50, s[4:5], s49
L_noinit2:
    s_barrier
    ds_read_b128 v[128:131], v224 offset:0
    ds_read_b128 v[132:135], v225 offset:0
    ds_read_b64_tr_b16 v[160:161], v226 offset:0
    ds_read_b64_tr_b16 v[162:163], v226 offset:1536
    ds_read_b64_tr_b16 v[164:165], v226 offset:12288
    ds_read_b64_tr_b16 v[166:167], v226 offset:13824
    ds_read_b64_tr_b16 v[172:173], v227 offset:12288
    ds_read_b64_tr_b16 v[174:175], v227 offset:13824
    ds_read_b64_tr_b16 v[168:169], v227 offset:0
    ds_read_b64_tr_b16 v[170:171], v227 offset:1536
    ds_read_b64_tr_b16 v[176:177], v228 offset:0
    ds_read_b64_tr_b16 v[178:179], v228 offset:1536
    ds_read_b64_tr_b16 v[180:181], v228 offset:12288
    ds_read_b64_tr_b16 v[182:183], v228 offset:13824
    ds_read_b128 v[136:139], v224 offset:2048
    ds_read_b128 v[140:143], v225 offset:2048
    ds_read_b128 v[144:147], v224 offset:4096
    ds_read_b128 v[148:151], v225 offset:4096
    s_waitcnt lgkmcnt(2)
.p2align 6
L1F:
    v_mfma_f32_16x16x32_bf16 v[0:3], v[160:163], v[128:131], v[0:3]
    ds_read_b128 v[152:155], v224 offset:6144
    ds_read_b128 v[156:159], v225 offset:6144
    v_mfma_f32_16x16x32_bf16 v[0:3], v[164:167], v[132:135], v[0:3]
    ds_read_b64_tr_b16 v[192:193], v229 offset:0
    ds_read_b64_tr_b16 v[194:195], v229 offset:1536
    v_mfma_f32_16x16x32_bf16 v[4:7], v[172:175], v[132:135], v[4:7]
    ds_read_b64_tr_b16 v[196:197], v229 offset:12288
    v_mfma_f32_16x16x32_bf16 v[4:7], v[168:171], v[128:131], v[4:7]
    ds_read_b64_tr_b16 v[198:199], v229 offset:13824
    v_mfma_f32_16x16x32_bf16 v[8:11], v[176:179], v[128:131], v[8:11]
    ds_read_b64_tr_b16 v[204:205], v230 offset:12288
    v_mfma_f32_16x16x32_bf16 v[8:11], v[180:183], v[132:135], v[8:11]
    ds_read_b64_tr_b16 v[206:207], v230 offset:13824
    v_mfma_f32_16x16x32_bf16 v[32:35], v[180:183], v[140:143], v[32:35]
    ds_read_b64_tr_b16 v[200:201], v230 offset:0
    v_mfma_f32_16x16x32_bf16 v[32:35], v[176:179], v[136:139], v[32:35]
    ds_read_b64_tr_b16 v[202:203], v230 offset:1536
    v_mfma_f32_16x16x32_bf16 v[28:31], v[168:171], v[136:139], v[28:31]
    ds_read_b64_tr_b16 v[208:209], v231 offset:0
    v_mfma_f32_16x16x32_bf16 v[28:31], v[172:175], v[140:143], v[28:31]
    ds_read_b64_tr_b16 v[210:211], v231 offset:1536
    v_mfma_f32_16x16x32_bf16 v[24:27], v[164:167], v[140:143], v[24:27]
    ds_read_b64_tr_b16 v[212:213], v231 offset:12288
    v_mfma_f32_16x16x32_bf16 v[24:27], v[160:163], v[136:139], v[24:27]
    ds_read_b64_tr_b16 v[214:215], v231 offset:13824
    s_waitcnt lgkmcnt(12)
    v_mfma_f32_16x16x32_bf16 v[48:51], v[160:163], v[144:147], v[48:51]
    s_add_u32 s34, s34, 1
    s_cmp_eq_u32 s34, 3
    v_mfma_f32_16x16x32_bf16 v[48:51], v[164:167], v[148:151], v[48:51]
    s_cselect_b32 s36, s33, s32
    s_cselect_b32 s34, 0, s34
    v_mfma_f32_16x16x32_bf16 v[52:55], v[172:175], v[148:151], v[52:55]
    v_add_u32_e64 v224, s36, v224
    v_mfma_f32_16x16x32_bf16 v[52:55], v[168:171], v[144:147], v[52:55]
    v_add_u32_e64 v225, s36, v225
    v_mfma_f32_16x16x32_bf16 v[56:59], v[176:179], v[144:147], v[56:59]
    v_add_u32_e64 v226, s36, v226
    v_mfma_f32_16x16x32_bf16 v[56:59], v[180:183], v[148:151], v[56:59]
    v_add_u32_e64 v227, s36, v227
    v_mfma_f32_16x16x32_bf16 v[80:83], v[180:183], v[156:159], v[80:83]
    v_add_u32_e64 v228, s36, v228
    v_mfma_f32_16x16x32_bf16 v[80:83], v[176:179], v[152:155], v[80:83]
    v_add_u32_e64 v229, s36, v229
    v_mfma_f32_16x16x32_bf16 v[76:79], v[168:171], v[152:155], v[76:79]
    v_add_u32_e64 v230, s36, v230
    v_mfma_f32_16x16x32_bf16 v[76:79], v[172:175], v[156:159], v[76:79]
    v_add_u32_e64 v231, s36, v231
    v_mfma_f32_16x16x32_bf16 v[72:75], v[164:167], v[156:159], v[72:75]
    s_sub_u32 s35, s35, 1
    s_cmp_eq_u32 s35, 0
    v_mfma_f32_16x16x32_bf16 v[72:75], v[160:163], v[152:155], v[72:75]
    s_waitcnt lgkmcnt(0)
    s_barrier
    v_mfma_f32_16x16x32_bf16 v[12:15], v[192:195], v[128:131], v[12:15]
    ds_read_b64_tr_b16 v[160:161], v226 offset:0
    v_mfma_f32_16x16x32_bf16 v[12:15], v[196:199], v[132:135], v[12:15]
    ds_read_b64_tr_b16 v[162:163], v226 offset:1536
    v_mfma_f32_16x16x32_bf16 v[16:19], v[204:207], v[132:135], v[16:19]
    ds_read_b64_tr_b16 v[164:165], v226 offset:12288
    v_mfma_f32_16x16x32_bf16 v[16:19], v[200:203], v[128:131], v[16:19]
    ds_read_b64_tr_b16 v[166:167], v226 offset:13824
    v_mfma_f32_16x16x32_bf16 v[20:23], v[208:211], v[128:131], v[20:23]
    ds_read_b64_tr_b16 v[172:173], v227 offset:12288
    v_mfma_f32_16x16x32_bf16 v[20:23], v[212:215], v[132:135], v[20:23]
    ds_read_b64_tr_b16 v[174:175], v227 offset:13824
    v_mfma_f32_16x16x32_bf16 v[44:47], v[212:215], v[140:143], v[44:47]
    ds_read_b128 v[128:131], v224 offset:0
    v_mfma_f32_16x16x32_bf16 v[44:47], v[208:211], v[136:139], v[44:47]
    ds_read_b128 v[132:135], v225 offset:0
    v_mfma_f32_16x16x32_bf16 v[40:43], v[200:203], v[136:139], v[40:43]
    ds_read_b64_tr_b16 v[168:169], v227 offset:0
    v_mfma_f32_16x16x32_bf16 v[40:43], v[204:207], v[140:143], v[40:43]
    ds_read_b64_tr_b16 v[170:171], v227 offset:1536
    v_mfma_f32_16x16x32_bf16 v[36:39], v[196:199], v[140:143], v[36:39]
    ds_read_b64_tr_b16 v[176:177], v228 offset:0
    v_mfma_f32_16x16x32_bf16 v[36:39], v[192:195], v[136:139], v[36:39]
    ds_read_b64_tr_b16 v[178:179], v228 offset:1536
    v_mfma_f32_16x16x32_bf16 v[60:63], v[192:195], v[144:147], v[60:63]
    ds_read_b128 v[136:139], v224 offset:2048
    v_mfma_f32_16x16x32_bf16 v[60:63], v[196:199], v[148:151], v[60:63]
    ds_read_b128 v[140:143], v225 offset:2048
    v_mfma_f32_16x16x32_bf16 v[64:67], v[204:207], v[148:151], v[64:67]
    ds_read_b64_tr_b16 v[180:181], v228 offset:12288
    v_mfma_f32_16x16x32_bf16 v[64:67], v[200:203], v[144:147], v[64:67]
    ds_read_b64_tr_b16 v[182:183], v228 offset:13824
    v_mfma_f32_16x16x32_bf16 v[68:71], v[208:211], v[144:147], v[68:71]
    v_mfma_f32_16x16x32_bf16 v[68:71], v[212:215], v[148:151], v[68:71]
    v_mfma_f32_16x16x32_bf16 v[92:95], v[212:215], v[156:159], v[92:95]
    ds_read_b128 v[144:147], v224 offset:4096
    v_mfma_f32_16x16x32_bf16 v[92:95], v[208:211], v[152:155], v[92:95]
    ds_read_b128 v[148:151], v225 offset:4096
    v_mfma_f32_16x16x32_bf16 v[88:91], v[200:203], v[152:155], v[88:91]
    v_mfma_f32_16x16x32_bf16 v[88:91], v[204:207], v[156:159], v[88:91]
    v_mfma_f32_16x16x32_bf16 v[84:87], v[196:199], v[156:159], v[84:87]
    v_mfma_f32_16x16x32_bf16 v[84:87], v[192:195], v[152:155], v[84:87]
    s_waitcnt lgkmcnt(2)
    s_cbranch_scc0 L1F
L_lastAF:
    v_mfma_f32_16x16x32_bf16 v[0:3], v[160:163], v[128:131], v[0:3]
    ds_read_b128 v[152:155], v224 offset:6144
    ds_read_b128 v[156:159], v225 offset:6144
    v_mfma_f32_16x16x32_bf16 v[0:3], v[164:167], v[132:135], v[0:3]
    ds_read_b64_tr_b16 v[192:193], v229 offset:0
    ds_read_b64_tr_b16 v[194:195], v229 offset:1536
    v_mfma_f32_16x16x32_bf16 v[4:7], v[172:175], v[132:135], v[4:7]
    ds_read_b64_tr_b16 v[196:197], v229 offset:12288
    ds_read_b64_tr_b16 v[198:199], v229 offset:13824
    v_mfma_f32_16x16x32_bf16 v[4:7], v[168:171], v[128:131], v[4:7]
    ds_read_b64_tr_b16 v[204:205], v230 offset:12288
    ds_read_b64_tr_b16 v[206:207], v230 offset:13824
    v_mfma_f32_16x16x32_bf16 v[8:11], v[176:179], v[128:131], v[8:11]
    ds_read_b64_tr_b16 v[200:201], v230 offset:0
    ds_read_b64_tr_b16 v[202:203], v230 offset:1536
    v_maximum3_f32 v0, v0, 0, 0
    v_mfma_f32_16x16x32_bf16 v[8:11], v[180:183], v[132:135], v[8:11]
    ds_read_b64_tr_b16 v[208:209], v231 offset:0
    ds_read_b64_tr_b16 v[210:211], v231 offset:1536
    v_maximum3_f32 v1, v1, 0, 0
    v_mfma_f32_16x16x32_bf16 v[32:35], v[180:183], v[140:143], v[32:35]
    ds_read_b64_tr_b16 v[212:213], v231 offset:12288
    ds_read_b64_tr_b16 v[214:215], v231 offset:13824
    v_maximum3_f32 v2, v2, 0, 0
    v_mfma_f32_16x16x32_bf16 v[32:35], v[176:179], v[136:139], v[32:35]
    v_maximum3_f32 v3, v3, 0, 0
    v_cvt_pk_bf16_f32 v3, v2, v3
    v_cvt_pk_bf16_f32 v2, v0, v1
    v_mfma_f32_16x16x32_bf16 v[28:31], v[168:171], v[136:139], v[28:31]
    v_maximum3_f32 v4, v4, 0, 0
    v_maximum3_f32 v5, v5, 0, 0
    v_maximum3_f32 v6, v6, 0, 0
    v_mfma_f32_16x16x32_bf16 v[28:31], v[172:175], v[140:143], v[28:31]
    v_maximum3_f32 v7, v7, 0, 0
    v_cvt_pk_bf16_f32 v4, v4, v5
    v_cvt_pk_bf16_f32 v5, v6, v7
    v_mfma_f32_16x16x32_bf16 v[24:27], v[164:167], v[140:143], v[24:27]
    buffer_store_dwordx4 v[2:5], v253, s[24:27], s44 offen offset:0 sc1
    v_maximum3_f32 v8, v8, 0, 0
    v_maximum3_f32 v9, v9, 0, 0
    v_mfma_f32_16x16x32_bf16 v[24:27], v[160:163], v[136:139], v[24:27]
    v_maximum3_f32 v10, v10, 0, 0
    v_maximum3_f32 v11, v11, 0, 0
    v_cvt_pk_bf16_f32 v11, v10, v11
    s_waitcnt lgkmcnt(12)
    v_mfma_f32_16x16x32_bf16 v[48:51], v[160:163], v[144:147], v[48:51]
    v_cvt_pk_bf16_f32 v10, v8, v9
    v_maximum3_f32 v32, v32, 0, 0
    v_maximum3_f32 v33, v33, 0, 0
    v_mfma_f32_16x16x32_bf16 v[48:51], v[164:167], v[148:151], v[48:51]
    v_maximum3_f32 v34, v34, 0, 0
    v_maximum3_f32 v35, v35, 0, 0
    v_cvt_pk_bf16_f32 v35, v34, v35
    s_waitcnt lgkmcnt(0)
    s_barrier
    v_mfma_f32_16x16x32_bf16 v[52:55], v[172:175], v[148:151], v[52:55]
    v_cvt_pk_bf16_f32 v34, v32, v33
    v_maximum3_f32 v28, v28, 0, 0
    v_maximum3_f32 v29, v29, 0, 0
    v_mfma_f32_16x16x32_bf16 v[52:55], v[168:171], v[144:147], v[52:55]
    v_maximum3_f32 v30, v30, 0, 0
    v_maximum3_f32 v31, v31, 0, 0
    v_cvt_pk_bf16_f32 v28, v28, v29
    v_mfma_f32_16x16x32_bf16 v[56:59], v[176:179], v[144:147], v[56:59]
    v_cvt_pk_bf16_f32 v29, v30, v31
    v_maximum3_f32 v24, v24, 0, 0
    v_maximum3_f32 v25, v25, 0, 0
    v_mfma_f32_16x16x32_bf16 v[56:59], v[180:183], v[148:151], v[56:59]
    v_maximum3_f32 v26, v26, 0, 0
    v_maximum3_f32 v27, v27, 0, 0
    v_cvt_pk_bf16_f32 v27, v26, v27
    v_mfma_f32_16x16x32_bf16 v[80:83], v[180:183], v[156:159], v[80:83]
    v_cvt_pk_bf16_f32 v26, v24, v25
    buffer_store_dwordx4 v[26:29], v253, s[24:27], s44 offen offset:2048 sc1
    v_maximum3_f32 v48, v48, 0, 0
    v_mfma_f32_16x16x32_bf16 v[80:83], v[176:179], v[152:155], v[80:83]
    v_maximum3_f32 v49, v49, 0, 0
    v_maximum3_f32 v50, v50, 0, 0
    v_maximum3_f32 v51, v51, 0, 0
    v_mfma_f32_16x16x32_bf16 v[76:79], v[168:171], v[152:155], v[76:79]
    v_cvt_pk_bf16_f32 v51, v50, v51
    v_cvt_pk_bf16_f32 v50, v48, v49
    v_maximum3_f32 v52, v52, 0, 0
    v_mfma_f32_16x16x32_bf16 v[76:79], v[172:175], v[156:159], v[76:79]
    v_maximum3_f32 v53, v53, 0, 0
    v_maximum3_f32 v54, v54, 0, 0
    v_maximum3_f32 v55, v55, 0, 0
    v_mfma_f32_16x16x32_bf16 v[72:75], v[164:167], v[156:159], v[72:75]
    v_cvt_pk_bf16_f32 v52, v52, v53
    v_cvt_pk_bf16_f32 v53, v54, v55
    buffer_store_dwordx4 v[50:53], v254, s[24:27], s44 offen offset:0 sc1
    v_mfma_f32_16x16x32_bf16 v[72:75], v[160:163], v[152:155], v[72:75]
    v_maximum3_f32 v56, v56, 0, 0
    v_maximum3_f32 v57, v57, 0, 0
    v_maximum3_f32 v58, v58, 0, 0
    v_mfma_f32_16x16x32_bf16 v[12:15], v[192:195], v[128:131], v[12:15]
    v_maximum3_f32 v59, v59, 0, 0
    v_cvt_pk_bf16_f32 v59, v58, v59
    v_cvt_pk_bf16_f32 v58, v56, v57
    v_mfma_f32_16x16x32_bf16 v[12:15], v[196:199], v[132:135], v[12:15]
    v_maximum3_f32 v80, v80, 0, 0
    v_maximum3_f32 v81, v81, 0, 0
    v_maximum3_f32 v82, v82, 0, 0
    v_mfma_f32_16x16x32_bf16 v[16:19], v[204:207], v[132:135], v[16:19]
    v_maximum3_f32 v83, v83, 0, 0
    v_cvt_pk_bf16_f32 v83, v82, v83
    v_cvt_pk_bf16_f32 v82, v80, v81
    v_mfma_f32_16x16x32_bf16 v[16:19], v[200:203], v[128:131], v[16:19]
    v_maximum3_f32 v76, v76, 0, 0
    v_maximum3_f32 v77, v77, 0, 0
    v_maximum3_f32 v78, v78, 0, 0
    v_mfma_f32_16x16x32_bf16 v[20:23], v[208:211], v[128:131], v[20:23]
    v_maximum3_f32 v79, v79, 0, 0
    v_cvt_pk_bf16_f32 v76, v76, v77
    v_cvt_pk_bf16_f32 v77, v78, v79
    v_mfma_f32_16x16x32_bf16 v[20:23], v[212:215], v[132:135], v[20:23]
    v_maximum3_f32 v72, v72, 0, 0
    v_maximum3_f32 v73, v73, 0, 0
    v_maximum3_f32 v74, v74, 0, 0
    v_mfma_f32_16x16x32_bf16 v[44:47], v[212:215], v[140:143], v[44:47]
    v_maximum3_f32 v75, v75, 0, 0
    v_cvt_pk_bf16_f32 v75, v74, v75
    v_cvt_pk_bf16_f32 v74, v72, v73
    v_mfma_f32_16x16x32_bf16 v[44:47], v[208:211], v[136:139], v[44:47]
    buffer_store_dwordx4 v[74:77], v254, s[24:27], s44 offen offset:2048 sc1
    v_maximum3_f32 v12, v12, 0, 0
    v_maximum3_f32 v13, v13, 0, 0
    v_mfma_f32_16x16x32_bf16 v[40:43], v[200:203], v[136:139], v[40:43]
    v_maximum3_f32 v14, v14, 0, 0
    v_maximum3_f32 v15, v15, 0, 0
    v_cvt_pk_bf16_f32 v12, v12, v13
    v_mfma_f32_16x16x32_bf16 v[40:43], v[204:207], v[140:143], v[40:43]
    v_cvt_pk_bf16_f32 v13, v14, v15
    buffer_store_dwordx4 v[10:13], v253, s[24:27], s45 offen offset:0 sc1
    v_maximum3_f32 v16, v16, 0, 0
    v_mfma_f32_16x16x32_bf16 v[36:39], v[196:199], v[140:143], v[36:39]
    v_maximum3_f32 v17, v17, 0, 0
    v_maximum3_f32 v18, v18, 0, 0
    v_maximum3_f32 v19, v19, 0, 0
    v_mfma_f32_16x16x32_bf16 v[36:39], v[192:195], v[136:139], v[36:39]
    v_cvt_pk_bf16_f32 v19, v18, v19
    v_cvt_pk_bf16_f32 v18, v16, v17
    v_maximum3_f32 v20, v20, 0, 0
    v_mfma_f32_16x16x32_bf16 v[60:63], v[192:195], v[144:147], v[60:63]
    v_maximum3_f32 v21, v21, 0, 0
    v_maximum3_f32 v22, v22, 0, 0
    v_maximum3_f32 v23, v23, 0, 0
    v_mfma_f32_16x16x32_bf16 v[60:63], v[196:199], v[148:151], v[60:63]
    v_cvt_pk_bf16_f32 v20, v20, v21
    v_cvt_pk_bf16_f32 v21, v22, v23
    buffer_store_dwordx4 v[18:21], v253, s[24:27], s46 offen offset:0 sc1
    v_mfma_f32_16x16x32_bf16 v[64:67], v[204:207], v[148:151], v[64:67]
    v_maximum3_f32 v44, v44, 0, 0
    v_maximum3_f32 v45, v45, 0, 0
    v_maximum3_f32 v46, v46, 0, 0
    v_mfma_f32_16x16x32_bf16 v[64:67], v[200:203], v[144:147], v[64:67]
    v_maximum3_f32 v47, v47, 0, 0
    v_cvt_pk_bf16_f32 v44, v44, v45
    v_cvt_pk_bf16_f32 v45, v46, v47
    v_mfma_f32_16x16x32_bf16 v[68:71], v[208:211], v[144:147], v[68:71]
    v_maximum3_f32 v40, v40, 0, 0
    v_maximum3_f32 v41, v41, 0, 0
    v_maximum3_f32 v42, v42, 0, 0
    v_mfma_f32_16x16x32_bf16 v[68:71], v[212:215], v[148:151], v[68:71]
    v_maximum3_f32 v43, v43, 0, 0
    v_cvt_pk_bf16_f32 v43, v42, v43
    v_cvt_pk_bf16_f32 v42, v40, v41
    v_mfma_f32_16x16x32_bf16 v[92:95], v[212:215], v[156:159], v[92:95]
    buffer_store_dwordx4 v[42:45], v253, s[24:27], s46 offen offset:2048 sc1
    v_maximum3_f32 v36, v36, 0, 0
    v_maximum3_f32 v37, v37, 0, 0
    v_mfma_f32_16x16x32_bf16 v[92:95], v[208:211], v[152:155], v[92:95]
    v_maximum3_f32 v38, v38, 0, 0
    v_maximum3_f32 v39, v39, 0, 0
    v_cvt_pk_bf16_f32 v36, v36, v37
    v_mfma_f32_16x16x32_bf16 v[88:91], v[200:203], v[152:155], v[88:91]
    v_cvt_pk_bf16_f32 v37, v38, v39
    buffer_store_dwordx4 v[34:37], v253, s[24:27], s45 offen offset:2048 sc1
    v_maximum3_f32 v60, v60, 0, 0
    v_mfma_f32_16x16x32_bf16 v[88:91], v[204:207], v[156:159], v[88:91]
    v_maximum3_f32 v61, v61, 0, 0
    v_maximum3_f32 v62, v62, 0, 0
    v_maximum3_f32 v63, v63, 0, 0
    v_mfma_f32_16x16x32_bf16 v[84:87], v[196:199], v[156:159], v[84:87]
    v_cvt_pk_bf16_f32 v60, v60, v61
    v_cvt_pk_bf16_f32 v61, v62, v63
    buffer_store_dwordx4 v[58:61], v254, s[24:27], s45 offen offset:0 sc1
    v_mfma_f32_16x16x32_bf16 v[84:87], v[192:195], v[152:155], v[84:87]
    v_maximum3_f32 v64, v64, 0, 0
    v_maximum3_f32 v65, v65, 0, 0
    v_maximum3_f32 v66, v66, 0, 0
    v_maximum3_f32 v67, v67, 0, 0
    v_cvt_pk_bf16_f32 v67, v66, v67
    v_cvt_pk_bf16_f32 v66, v64, v65
    v_maximum3_f32 v68, v68, 0, 0
    v_maximum3_f32 v69, v69, 0, 0
    v_maximum3_f32 v70, v70, 0, 0
    v_maximum3_f32 v71, v71, 0, 0
    v_cvt_pk_bf16_f32 v68, v68, v69
    v_cvt_pk_bf16_f32 v69, v70, v71
    buffer_store_dwordx4 v[66:69], v254, s[24:27], s46 offen offset:0 sc1
    v_maximum3_f32 v92, v92, 0, 0
    v_maximum3_f32 v93, v93, 0, 0
    v_maximum3_f32 v94, v94, 0, 0
    v_maximum3_f32 v95, v95, 0, 0
    v_cvt_pk_bf16_f32 v92, v92, v93
    v_cvt_pk_bf16_f32 v93, v94, v95
    v_maximum3_f32 v88, v88, 0, 0
    v_maximum3_f32 v89, v89, 0, 0
    v_maximum3_f32 v90, v90, 0, 0
    v_maximum3_f32 v91, v91, 0, 0
    v_cvt_pk_bf16_f32 v91, v90, v91
    v_cvt_pk_bf16_f32 v90, v88, v89
    buffer_store_dwordx4 v[90:93], v254, s[24:27], s46 offen offset:2048 sc1
    v_maximum3_f32 v84, v84, 0, 0
    v_maximum3_f32 v85, v85, 0, 0
    v_maximum3_f32 v86, v86, 0, 0
    v_maximum3_f32 v87, v87, 0, 0
    v_cvt_pk_bf16_f32 v84, v84, v85
    v_cvt_pk_bf16_f32 v85, v86, v87
    buffer_store_dwordx4 v[82:85], v254, s[24:27], s45 offen offset:2048 sc1
    ds_write_b128 v245, v[2:5] offset:0
    ds_write_b128 v245, v[26:29] offset:2048
    ds_write_b128 v245, v[50:53] offset:4096
    ds_write_b128 v245, v[74:77] offset:6144
    ds_write_b128 v246, v[10:13] offset:0
    ds_write_b128 v247, v[18:21] offset:0
    ds_write_b128 v247, v[42:45] offset:2048
    ds_write_b128 v246, v[34:37] offset:2048
    ds_write_b128 v246, v[58:61] offset:4096
    ds_write_b128 v247, v[66:69] offset:4096
    ds_write_b128 v247, v[90:93] offset:6144
    ds_write_b128 v246, v[82:85] offset:6144
    s_mov_b32 s35, 16
    s_branch L_g2
L_g1H:
    s_lshl_b32 s30, s29, 8
    v_lshl_add_u32 v226, v248, 9, v249
    v_lshl_add_u32 v226, v251, 5, v226
    v_add_u32 v226, s30, v226
    v_xor_b32 v227, 32, v226
    v_xor_b32 v228, 64, v226
    v_xor_b32 v229, 96, v226
    v_xor_b32 v230, 128, v226
    v_xor_b32 v231, 160, v226
    v_xor_b32 v232, 192, v226
    v_xor_b32 v233, 224, v226
    s_mul_i32 s30, s13, 532480
    s_mul_i32 s31, s11, 66560
    s_add_u32 s30, s30, s31
    s_add_u32 s30, s30, 14745600
    v_add_u32 v242, s30, v241
    s_lshl_b32 s37, s11, 16
    s_add_u32 s37, s37, 393216
    s_lshl_b32 s30, s41, 7
    s_add_u32 s30, s30, s48
    s_add_u32 s30, s30, 256
    v_mov_b32 v243, s30
    s_add_u32 s37, s37, s15
    s_cmp_eq_u32 s29, 0
    s_mov_b32 s30, 0
    s_cselect_b32 s30, 98304, s30
    v_add_u32 v245, s30, v253
    s_mov_b32 s44, 32768
    s_cselect_b32 s44, 0, s44
    s_mov_b32 s30, 1024
    s_cselect_b32 s30, 99328, s30
    v_add_u32 v246, s30, v253
    s_mov_b32 s45, 33792
    s_cselect_b32 s45, 1024, s45
    s_mov_b32 s30, 32768
    s_cselect_b32 s30, 131072, s30
    v_add_u32 v247, s30, v253
    s_mov_b32 s46, 49152
    s_cselect_b32 s46, 16384, s46
    s_mov_b32 s30, 33792
    s_cselect_b32 s30, 132096, s30
    v_add_u32 v248, s30, v253
    s_mov_b32 s47, 50176
    s_cselect_b32 s47, 17408, s47
    s_add_u32 s44, s44, s37
    s_add_u32 s45, s45, s37
    s_add_u32 s46, s46, s37
    s_add_u32 s47, s47, s37
    s_waitcnt lgkmcnt(0)
    s_mov_b32 s8, s6
    s_mov_b32 s9, s7
    s_mov_b32 s24, s6
    s_and_b32 s25, s7, 0xffff
    s_mov_b32 s20, s86
    s_and_b32 s21, s87, 0xffff
    s_barrier
    ds_read_b128 v[128:131], v224 offset:0
    ds_read_b128 v[132:135], v225 offset:0
    ds_read_b64_tr_b16 v[160:161], v226 offset:0
    ds_read_b64_tr_b16 v[162:163], v226 offset:2048
    ds_read_b64_tr_b16 v[164:165], v226 offset:16384
    ds_read_b64_tr_b16 v[166:167], v226 offset:18432
    ds_read_b64_tr_b16 v[172:173], v227 offset:16384
    ds_read_b64_tr_b16 v[174:175], v227 offset:18432
    ds_read_b64_tr_b16 v[168:169], v227 offset:0
    ds_read_b64_tr_b16 v[170:171], v227 offset:2048
    ds_read_b64_tr_b16 v[176:177], v228 offset:0
    ds_read_b64_tr_b16 v[178:179], v228 offset:2048
    ds_read_b64_tr_b16 v[180:181], v228 offset:16384
    ds_read_b64_tr_b16 v[182:183], v228 offset:18432
    ds_read_b64_tr_b16 v[188:189], v229 offset:16384
    ds_read_b64_tr_b16 v[190:191], v229 offset:18432
    ds_read_b64_tr_b16 v[184:185], v229 offset:0
    ds_read_b64_tr_b16 v[186:187], v229 offset:2048
    ds_read_b128 v[136:139], v224 offset:2048
    ds_read_b128 v[140:143], v225 offset:2048
    ds_read_b128 v[144:147], v224 offset:4096
    ds_read_b128 v[148:151], v225 offset:4096
    s_waitcnt lgkmcnt(2)
.p2align 6
L1H:
    v_mfma_f32_16x16x32_bf16 v[0:3], v[160:163], v[128:131], v[0:3]
    ds_read_b128 v[152:155], v224 offset:6144
    v_mfma_f32_16x16x32_bf16 v[0:3], v[164:167], v[132:135], v[0:3]
    ds_read_b128 v[156:159], v225 offset:6144
    v_mfma_f32_16x16x32_bf16 v[4:7], v[172:175], v[132:135], v[4:7]
    ds_read_b64_tr_b16 v[192:193], v230 offset:0
    v_mfma_f32_16x16x32_bf16 v[4:7], v[168:171], v[128:131], v[4:7]
    ds_read_b64_tr_b16 v[194:195], v230 offset:2048
    v_mfma_f32_16x16x32_bf16 v[8:11], v[176:179], v[128:131], v[8:11]
    ds_read_b64_tr_b16 v[196:197], v230 offset:16384
    v_mfma_f32_16x16x32_bf16 v[8:11], v[180:183], v[132:135], v[8:11]
    ds_read_b64_tr_b16 v[198:199], v230 offset:18432
    v_mfma_f32_16x16x32_bf16 v[12:15], v[188:191], v[132:135], v[12:15]
    ds_read_b64_tr_b16 v[204:205], v231 offset:16384
    v_mfma_f32_16x16x32_bf16 v[12:15], v[184:187], v[128:131], v[12:15]
    ds_read_b64_tr_b16 v[206:207], v231 offset:18432
    v_mfma_f32_16x16x32_bf16 v[44:47], v[184:187], v[136:139], v[44:47]
    ds_read_b64_tr_b16 v[200:201], v231 offset:0
    v_mfma_f32_16x16x32_bf16 v[44:47], v[188:191], v[140:143], v[44:47]
    ds_read_b64_tr_b16 v[202:203], v231 offset:2048
    v_mfma_f32_16x16x32_bf16 v[40:43], v[180:183], v[140:143], v[40:43]
    ds_read_b64_tr_b16 v[208:209], v232 offset:0
    v_mfma_f32_16x16x32_bf16 v[40:43], v[176:179], v[136:139], v[40:43]
    ds_read_b64_tr_b16 v[210:211], v232 offset:2048
    v_mfma_f32_16x16x32_bf16 v[36:39], v[168:171], v[136:139], v[36:39]
    ds_read_b64_tr_b16 v[212:213], v232 offset:16384
    v_mfma_f32_16x16x32_bf16 v[36:39], v[172:175], v[140:143], v[36:39]
    ds_read_b64_tr_b16 v[214:215], v232 offset:18432
    v_mfma_f32_16x16x32_bf16 v[32:35], v[164:167], v[140:143], v[32:35]
    ds_read_b64_tr_b16 v[220:221], v233 offset:16384
    v_mfma_f32_16x16x32_bf16 v[32:35], v[160:163], v[136:139], v[32:35]
    ds_read_b64_tr_b16 v[222:223], v233 offset:18432
    s_waitcnt lgkmcnt(12)
    v_mfma_f32_16x16x32_bf16 v[64:67], v[160:163], v[144:147], v[64:67]
    ds_read_b64_tr_b16 v[216:217], v233 offset:0
    v_mfma_f32_16x16x32_bf16 v[64:67], v[164:167], v[148:151], v[64:67]
    ds_read_b64_tr_b16 v[218:219], v233 offset:2048
    v_mfma_f32_16x16x32_bf16 v[68:71], v[172:175], v[148:151], v[68:71]
    s_add_u32 s34, s34, 1
    s_cmp_eq_u32 s34, 3
    v_mfma_f32_16x16x32_bf16 v[68:71], v[168:171], v[144:147], v[68:71]
    s_cselect_b32 s36, s33, s32
    s_cselect_b32 s34, 0, s34
    v_mfma_f32_16x16x32_bf16 v[72:75], v[176:179], v[144:147], v[72:75]
    v_add_u32_e64 v224, s36, v224
    v_mfma_f32_16x16x32_bf16 v[72:75], v[180:183], v[148:151], v[72:75]
    v_add_u32_e64 v225, s36, v225
    v_mfma_f32_16x16x32_bf16 v[76:79], v[188:191], v[148:151], v[76:79]
    v_add_u32_e64 v226, s36, v226
    v_mfma_f32_16x16x32_bf16 v[76:79], v[184:187], v[144:147], v[76:79]
    v_add_u32_e64 v227, s36, v227
    v_mfma_f32_16x16x32_bf16 v[108:111], v[184:187], v[152:155], v[108:111]
    v_add_u32_e64 v228, s36, v228
    v_mfma_f32_16x16x32_bf16 v[108:111], v[188:191], v[156:159], v[108:111]
    v_add_u32_e64 v229, s36, v229
    v_mfma_f32_16x16x32_bf16 v[104:107], v[180:183], v[156:159], v[104:107]
    v_add_u32_e64 v230, s36, v230
    v_mfma_f32_16x16x32_bf16 v[104:107], v[176:179], v[152:155], v[104:107]
    v_add_u32_e64 v231, s36, v231
    v_mfma_f32_16x16x32_bf16 v[100:103], v[168:171], v[152:155], v[100:103]
    v_add_u32_e64 v232, s36, v232
    v_mfma_f32_16x16x32_bf16 v[100:103], v[172:175], v[156:159], v[100:103]
    v_add_u32_e64 v233, s36, v233
    v_mfma_f32_16x16x32_bf16 v[96:99], v[164:167], v[156:159], v[96:99]
    s_sub_u32 s35, s35, 1
    s_cmp_eq_u32 s35, 0
    v_mfma_f32_16x16x32_bf16 v[96:99], v[160:163], v[152:155], v[96:99]
    s_waitcnt lgkmcnt(0)
    s_barrier
    v_mfma_f32_16x16x32_bf16 v[16:19], v[192:195], v[128:131], v[16:19]
    ds_read_b64_tr_b16 v[160:161], v226 offset:0
    v_mfma_f32_16x16x32_bf16 v[16:19], v[196:199], v[132:135], v[16:19]
    ds_read_b64_tr_b16 v[162:163], v226 offset:2048
    v_mfma_f32_16x16x32_bf16 v[20:23], v[204:207], v[132:135], v[20:23]
    ds_read_b64_tr_b16 v[164:165], v226 offset:16384
    v_mfma_f32_16x16x32_bf16 v[20:23], v[200:203], v[128:131], v[20:23]
    ds_read_b64_tr_b16 v[166:167], v226 offset:18432
    v_mfma_f32_16x16x32_bf16 v[24:27], v[208:211], v[128:131], v[24:27]
    ds_read_b64_tr_b16 v[172:173], v227 offset:16384
    v_mfma_f32_16x16x32_bf16 v[24:27], v[212:215], v[132:135], v[24:27]
    ds_read_b64_tr_b16 v[174:175], v227 offset:18432
    v_mfma_f32_16x16x32_bf16 v[28:31], v[220:223], v[132:135], v[28:31]
    ds_read_b64_tr_b16 v[168:169], v227 offset:0
    v_mfma_f32_16x16x32_bf16 v[28:31], v[216:219], v[128:131], v[28:31]
    ds_read_b64_tr_b16 v[170:171], v227 offset:2048
    v_mfma_f32_16x16x32_bf16 v[60:63], v[216:219], v[136:139], v[60:63]
    ds_read_b128 v[128:131], v224 offset:0
    v_mfma_f32_16x16x32_bf16 v[60:63], v[220:223], v[140:143], v[60:63]
    ds_read_b128 v[132:135], v225 offset:0
    v_mfma_f32_16x16x32_bf16 v[56:59], v[212:215], v[140:143], v[56:59]
    ds_read_b64_tr_b16 v[176:177], v228 offset:0
    v_mfma_f32_16x16x32_bf16 v[56:59], v[208:211], v[136:139], v[56:59]
    ds_read_b64_tr_b16 v[178:179], v228 offset:2048
    v_mfma_f32_16x16x32_bf16 v[52:55], v[200:203], v[136:139], v[52:55]
    ds_read_b64_tr_b16 v[180:181], v228 offset:16384
    v_mfma_f32_16x16x32_bf16 v[52:55], v[204:207], v[140:143], v[52:55]
    ds_read_b64_tr_b16 v[182:183], v228 offset:18432
    v_mfma_f32_16x16x32_bf16 v[48:51], v[196:199], v[140:143], v[48:51]
    ds_read_b64_tr_b16 v[188:189], v229 offset:16384
    v_mfma_f32_16x16x32_bf16 v[48:51], v[192:195], v[136:139], v[48:51]
    ds_read_b64_tr_b16 v[190:191], v229 offset:18432
    v_mfma_f32_16x16x32_bf16 v[80:83], v[192:195], v[144:147], v[80:83]
    ds_read_b128 v[136:139], v224 offset:2048
    v_mfma_f32_16x16x32_bf16 v[80:83], v[196:199], v[148:151], v[80:83]
    ds_read_b128 v[140:143], v225 offset:2048
    v_mfma_f32_16x16x32_bf16 v[84:87], v[204:207], v[148:151], v[84:87]
    ds_read_b64_tr_b16 v[184:185], v229 offset:0
    v_mfma_f32_16x16x32_bf16 v[84:87], v[200:203], v[144:147], v[84:87]
    ds_read_b64_tr_b16 v[186:187], v229 offset:2048
    v_mfma_f32_16x16x32_bf16 v[88:91], v[208:211], v[144:147], v[88:91]
    v_mfma_f32_16x16x32_bf16 v[88:91], v[212:215], v[148:151], v[88:91]
    v_mfma_f32_16x16x32_bf16 v[92:95], v[220:223], v[148:151], v[92:95]
    v_mfma_f32_16x16x32_bf16 v[92:95], v[216:219], v[144:147], v[92:95]
    v_mfma_f32_16x16x32_bf16 v[124:127], v[216:219], v[152:155], v[124:127]
    ds_read_b128 v[144:147], v224 offset:4096
    v_mfma_f32_16x16x32_bf16 v[124:127], v[220:223], v[156:159], v[124:127]
    ds_read_b128 v[148:151], v225 offset:4096
    v_mfma_f32_16x16x32_bf16 v[120:123], v[212:215], v[156:159], v[120:123]
    v_mfma_f32_16x16x32_bf16 v[120:123], v[208:211], v[152:155], v[120:123]
    v_mfma_f32_16x16x32_bf16 v[116:119], v[200:203], v[152:155], v[116:119]
    v_mfma_f32_16x16x32_bf16 v[116:119], v[204:207], v[156:159], v[116:119]
    v_mfma_f32_16x16x32_bf16 v[112:115], v[196:199], v[156:159], v[112:115]
    v_mfma_f32_16x16x32_bf16 v[112:115], v[192:195], v[152:155], v[112:115]
    s_waitcnt lgkmcnt(2)
    s_cbranch_scc0 L1H
L_lastAH:
    v_mfma_f32_16x16x32_bf16 v[0:3], v[160:163], v[128:131], v[0:3]
    ds_read_b128 v[152:155], v224 offset:6144
    ds_read_b128 v[156:159], v225 offset:6144
    v_mfma_f32_16x16x32_bf16 v[0:3], v[164:167], v[132:135], v[0:3]
    ds_read_b64_tr_b16 v[192:193], v230 offset:0
    ds_read_b64_tr_b16 v[194:195], v230 offset:2048
    v_mfma_f32_16x16x32_bf16 v[4:7], v[172:175], v[132:135], v[4:7]
    ds_read_b64_tr_b16 v[196:197], v230 offset:16384
    ds_read_b64_tr_b16 v[198:199], v230 offset:18432
    v_mfma_f32_16x16x32_bf16 v[4:7], v[168:171], v[128:131], v[4:7]
    ds_read_b64_tr_b16 v[204:205], v231 offset:16384
    ds_read_b64_tr_b16 v[206:207], v231 offset:18432
    v_mfma_f32_16x16x32_bf16 v[8:11], v[176:179], v[128:131], v[8:11]
    ds_read_b64_tr_b16 v[200:201], v231 offset:0
    ds_read_b64_tr_b16 v[202:203], v231 offset:2048
    v_maximum3_f32 v0, v0, 0, 0
    v_mfma_f32_16x16x32_bf16 v[8:11], v[180:183], v[132:135], v[8:11]
    ds_read_b64_tr_b16 v[208:209], v232 offset:0
    ds_read_b64_tr_b16 v[210:211], v232 offset:2048
    v_maximum3_f32 v1, v1, 0, 0
    v_mfma_f32_16x16x32_bf16 v[12:15], v[188:191], v[132:135], v[12:15]
    ds_read_b64_tr_b16 v[212:213], v232 offset:16384
    ds_read_b64_tr_b16 v[214:215], v232 offset:18432
    v_maximum3_f32 v2, v2, 0, 0
    v_mfma_f32_16x16x32_bf16 v[12:15], v[184:187], v[128:131], v[12:15]
    ds_read_b64_tr_b16 v[220:221], v233 offset:16384
    ds_read_b64_tr_b16 v[222:223], v233 offset:18432
    v_maximum3_f32 v3, v3, 0, 0
    v_mfma_f32_16x16x32_bf16 v[44:47], v[184:187], v[136:139], v[44:47]
    ds_read_b64_tr_b16 v[216:217], v233 offset:0
    ds_read_b64_tr_b16 v[218:219], v233 offset:2048
    v_cvt_pk_bf16_f32 v3, v2, v3
    v_mfma_f32_16x16x32_bf16 v[44:47], v[188:191], v[140:143], v[44:47]
    v_cvt_pk_bf16_f32 v2, v0, v1
    v_maximum3_f32 v4, v4, 0, 0
    v_maximum3_f32 v5, v5, 0, 0
    v_mfma_f32_16x16x32_bf16 v[40:43], v[180:183], v[140:143], v[40:43]
    v_maximum3_f32 v6, v6, 0, 0
    v_maximum3_f32 v7, v7, 0, 0
    v_cvt_pk_bf16_f32 v4, v4, v5
    v_mfma_f32_16x16x32_bf16 v[40:43], v[176:179], v[136:139], v[40:43]
    v_cvt_pk_bf16_f32 v5, v6, v7
    buffer_store_dwordx4 v[2:5], v253, s[24:27], s44 offen offset:0 sc1
    ds_write_b128 v245, v[2:5] offset:0
    v_mfma_f32_16x16x32_bf16 v[36:39], v[168:171], v[136:139], v[36:39]
    v_maximum3_f32 v8, v8, 0, 0
    v_maximum3_f32 v9, v9, 0, 0
    v_maximum3_f32 v10, v10, 0, 0
    v_mfma_f32_16x16x32_bf16 v[36:39], v[172:175], v[140:143], v[36:39]
    v_maximum3_f32 v11, v11, 0, 0
    v_cvt_pk_bf16_f32 v11, v10, v11
    v_cvt_pk_bf16_f32 v10, v8, v9
    v_mfma_f32_16x16x32_bf16 v[32:35], v[164:167], v[140:143], v[32:35]
    v_maximum3_f32 v12, v12, 0, 0
    v_maximum3_f32 v13, v13, 0, 0
    v_maximum3_f32 v14, v14, 0, 0
    v_mfma_f32_16x16x32_bf16 v[32:35], v[160:163], v[136:139], v[32:35]
    v_maximum3_f32 v15, v15, 0, 0
    v_cvt_pk_bf16_f32 v12, v12, v13
    v_cvt_pk_bf16_f32 v13, v14, v15
    s_waitcnt lgkmcnt(1)
    s_barrier
    v_mfma_f32_16x16x32_bf16 v[64:67], v[160:163], v[144:147], v[64:67]
    buffer_store_dwordx4 v[10:13], v253, s[24:27], s45 offen offset:0 sc1
    ds_write_b128 v246, v[10:13] offset:0
    v_maximum3_f32 v44, v44, 0, 0
    v_mfma_f32_16x16x32_bf16 v[64:67], v[164:167], v[148:151], v[64:67]
    v_maximum3_f32 v45, v45, 0, 0
    v_maximum3_f32 v46, v46, 0, 0
    v_maximum3_f32 v47, v47, 0, 0
    v_mfma_f32_16x16x32_bf16 v[68:71], v[172:175], v[148:151], v[68:71]
    v_cvt_pk_bf16_f32 v44, v44, v45
    v_cvt_pk_bf16_f32 v45, v46, v47
    v_maximum3_f32 v40, v40, 0, 0
    v_mfma_f32_16x16x32_bf16 v[68:71], v[168:171], v[144:147], v[68:71]
    v_maximum3_f32 v41, v41, 0, 0
    v_maximum3_f32 v42, v42, 0, 0
    v_maximum3_f32 v43, v43, 0, 0
    v_mfma_f32_16x16x32_bf16 v[72:75], v[176:179], v[144:147], v[72:75]
    v_cvt_pk_bf16_f32 v43, v42, v43
    v_cvt_pk_bf16_f32 v42, v40, v41
    buffer_store_dwordx4 v[42:45], v253, s[24:27], s45 offen offset:2048 sc1
    v_mfma_f32_16x16x32_bf16 v[72:75], v[180:183], v[148:151], v[72:75]
    ds_write_b128 v246, v[42:45] offset:2048
    v_maximum3_f32 v36, v36, 0, 0
    v_maximum3_f32 v37, v37, 0, 0
    v_mfma_f32_16x16x32_bf16 v[76:79], v[188:191], v[148:151], v[76:79]
    v_maximum3_f32 v38, v38, 0, 0
    v_maximum3_f32 v39, v39, 0, 0
    v_cvt_pk_bf16_f32 v36, v36, v37
    v_mfma_f32_16x16x32_bf16 v[76:79], v[184:187], v[144:147], v[76:79]
    v_cvt_pk_bf16_f32 v37, v38, v39
    v_maximum3_f32 v32, v32, 0, 0
    v_maximum3_f32 v33, v33, 0, 0
    v_mfma_f32_16x16x32_bf16 v[108:111], v[184:187], v[152:155], v[108:111]
    v_maximum3_f32 v34, v34, 0, 0
    v_maximum3_f32 v35, v35, 0, 0
    v_cvt_pk_bf16_f32 v35, v34, v35
    v_mfma_f32_16x16x32_bf16 v[108:111], v[188:191], v[156:159], v[108:111]
    v_cvt_pk_bf16_f32 v34, v32, v33
    buffer_store_dwordx4 v[34:37], v253, s[24:27], s44 offen offset:2048 sc1
    ds_write_b128 v245, v[34:37] offset:2048
    v_mfma_f32_16x16x32_bf16 v[104:107], v[180:183], v[156:159], v[104:107]
    v_maximum3_f32 v64, v64, 0, 0
    v_maximum3_f32 v65, v65, 0, 0
    v_maximum3_f32 v66, v66, 0, 0
    v_mfma_f32_16x16x32_bf16 v[104:107], v[176:179], v[152:155], v[104:107]
    v_maximum3_f32 v67, v67, 0, 0
    v_cvt_pk_bf16_f32 v67, v66, v67
    v_cvt_pk_bf16_f32 v66, v64, v65
    v_mfma_f32_16x16x32_bf16 v[100:103], v[168:171], v[152:155], v[100:103]
    v_maximum3_f32 v68, v68, 0, 0
    v_maximum3_f32 v69, v69, 0, 0
    v_maximum3_f32 v70, v70, 0, 0
    v_mfma_f32_16x16x32_bf16 v[100:103], v[172:175], v[156:159], v[100:103]
    v_maximum3_f32 v71, v71, 0, 0
    v_cvt_pk_bf16_f32 v68, v68, v69
    v_cvt_pk_bf16_f32 v69, v70, v71
    v_mfma_f32_16x16x32_bf16 v[96:99], v[164:167], v[156:159], v[96:99]
    buffer_store_dwordx4 v[66:69], v254, s[24:27], s44 offen offset:0 sc1
    ds_write_b128 v245, v[66:69] offset:4096
    v_maximum3_f32 v72, v72, 0, 0
    v_mfma_f32_16x16x32_bf16 v[96:99], v[160:163], v[152:155], v[96:99]
    v_maximum3_f32 v73, v73, 0, 0
    v_maximum3_f32 v74, v74, 0, 0
    v_maximum3_f32 v75, v75, 0, 0
    v_mfma_f32_16x16x32_bf16 v[16:19], v[192:195], v[128:131], v[16:19]
    v_cvt_pk_bf16_f32 v75, v74, v75
    v_cvt_pk_bf16_f32 v74, v72, v73
    v_maximum3_f32 v76, v76, 0, 0
    v_mfma_f32_16x16x32_bf16 v[16:19], v[196:199], v[132:135], v[16:19]
    v_maximum3_f32 v77, v77, 0, 0
    v_maximum3_f32 v78, v78, 0, 0
    v_maximum3_f32 v79, v79, 0, 0
    v_mfma_f32_16x16x32_bf16 v[20:23], v[204:207], v[132:135], v[20:23]
    v_cvt_pk_bf16_f32 v76, v76, v77
    v_cvt_pk_bf16_f32 v77, v78, v79
    buffer_store_dwordx4 v[74:77], v254, s[24:27], s45 offen offset:0 sc1
    v_mfma_f32_16x16x32_bf16 v[20:23], v[200:203], v[128:131], v[20:23]
    ds_write_b128 v246, v[74:77] offset:4096
    v_maximum3_f32 v108, v108, 0, 0
    v_maximum3_f32 v109, v109, 0, 0
    v_mfma_f32_16x16x32_bf16 v[24:27], v[208:211], v[128:131], v[24:27]
    v_maximum3_f32 v110, v110, 0, 0
    v_maximum3_f32 v111, v111, 0, 0
    v_cvt_pk_bf16_f32 v108, v108, v109
    v_mfma_f32_16x16x32_bf16 v[24:27], v[212:215], v[132:135], v[24:27]
    v_cvt_pk_bf16_f32 v109, v110, v111
    v_maximum3_f32 v104, v104, 0, 0
    v_maximum3_f32 v105, v105, 0, 0
    v_mfma_f32_16x16x32_bf16 v[28:31], v[220:223], v[132:135], v[28:31]
    v_maximum3_f32 v106, v106, 0, 0
    v_maximum3_f32 v107, v107, 0, 0
    v_cvt_pk_bf16_f32 v107, v106, v107
    v_mfma_f32_16x16x32_bf16 v[28:31], v[216:219], v[128:131], v[28:31]
    v_cvt_pk_bf16_f32 v106, v104, v105
    buffer_store_dwordx4 v[106:109], v254, s[24:27], s45 offen offset:2048 sc1
    ds_write_b128 v246, v[106:109] offset:6144
    v_mfma_f32_16x16x32_bf16 v[60:63], v[216:219], v[136:139], v[60:63]
    v_maximum3_f32 v100, v100, 0, 0
    v_maximum3_f32 v101, v101, 0, 0
    v_maximum3_f32 v102, v102, 0, 0
    v_mfma_f32_16x16x32_bf16 v[60:63], v[220:223], v[140:143], v[60:63]
    v_maximum3_f32 v103, v103, 0, 0
    v_cvt_pk_bf16_f32 v100, v100, v101
    v_cvt_pk_bf16_f32 v101, v102, v103
    v_mfma_f32_16x16x32_bf16 v[56:59], v[212:215], v[140:143], v[56:59]
    v_maximum3_f32 v96, v96, 0, 0
    v_maximum3_f32 v97, v97, 0, 0
    v_maximum3_f32 v98, v98, 0, 0
    v_mfma_f32_16x16x32_bf16 v[56:59], v[208:211], v[136:139], v[56:59]
    v_maximum3_f32 v99, v99, 0, 0
    v_cvt_pk_bf16_f32 v99, v98, v99
    v_cvt_pk_bf16_f32 v98, v96, v97
    v_mfma_f32_16x16x32_bf16 v[52:55], v[200:203], v[136:139], v[52:55]
    buffer_store_dwordx4 v[98:101], v254, s[24:27], s44 offen offset:2048 sc1
    ds_write_b128 v245, v[98:101] offset:6144
    v_maximum3_f32 v16, v16, 0, 0
    v_mfma_f32_16x16x32_bf16 v[52:55], v[204:207], v[140:143], v[52:55]
    v_maximum3_f32 v17, v17, 0, 0
    v_maximum3_f32 v18, v18, 0, 0
    v_maximum3_f32 v19, v19, 0, 0
    v_mfma_f32_16x16x32_bf16 v[48:51], v[196:199], v[140:143], v[48:51]
    v_cvt_pk_bf16_f32 v19, v18, v19
    v_cvt_pk_bf16_f32 v18, v16, v17
    v_maximum3_f32 v20, v20, 0, 0
    v_mfma_f32_16x16x32_bf16 v[48:51], v[192:195], v[136:139], v[48:51]
    v_maximum3_f32 v21, v21, 0, 0
    v_maximum3_f32 v22, v22, 0, 0
    v_maximum3_f32 v23, v23, 0, 0
    v_mfma_f32_16x16x32_bf16 v[80:83], v[192:195], v[144:147], v[80:83]
    v_cvt_pk_bf16_f32 v20, v20, v21
    v_cvt_pk_bf16_f32 v21, v22, v23
    ds_write_b128 v247, v[18:21] offset:0
    v_mfma_f32_16x16x32_bf16 v[80:83], v[196:199], v[148:151], v[80:83]
    v_maximum3_f32 v24, v24, 0, 0
    v_maximum3_f32 v25, v25, 0, 0
    v_maximum3_f32 v26, v26, 0, 0
    v_mfma_f32_16x16x32_bf16 v[84:87], v[204:207], v[148:151], v[84:87]
    v_maximum3_f32 v27, v27, 0, 0
    v_cvt_pk_bf16_f32 v27, v26, v27
    v_cvt_pk_bf16_f32 v26, v24, v25
    v_mfma_f32_16x16x32_bf16 v[84:87], v[200:203], v[144:147], v[84:87]
    v_maximum3_f32 v28, v28, 0, 0
    v_maximum3_f32 v29, v29, 0, 0
    v_maximum3_f32 v30, v30, 0, 0
    v_mfma_f32_16x16x32_bf16 v[88:91], v[208:211], v[144:147], v[88:91]
    v_maximum3_f32 v31, v31, 0, 0
    v_cvt_pk_bf16_f32 v28, v28, v29
    v_cvt_pk_bf16_f32 v29, v30, v31
    v_mfma_f32_16x16x32_bf16 v[88:91], v[212:215], v[148:151], v[88:91]
    ds_write_b128 v248, v[26:29] offset:0
    v_maximum3_f32 v60, v60, 0, 0
    v_maximum3_f32 v61, v61, 0, 0
    v_mfma_f32_16x16x32_bf16 v[92:95], v[220:223], v[148:151], v[92:95]
    v_maximum3_f32 v62, v62, 0, 0
    v_maximum3_f32 v63, v63, 0, 0
    v_cvt_pk_bf16_f32 v60, v60, v61
    v_mfma_f32_16x16x32_bf16 v[92:95], v[216:219], v[144:147], v[92:95]
    v_cvt_pk_bf16_f32 v61, v62, v63
    v_maximum3_f32 v56, v56, 0, 0
    v_maximum3_f32 v57, v57, 0, 0
    v_mfma_f32_16x16x32_bf16 v[124:127], v[216:219], v[152:155], v[124:127]
    v_maximum3_f32 v58, v58, 0, 0
    v_maximum3_f32 v59, v59, 0, 0
    v_cvt_pk_bf16_f32 v59, v58, v59
    v_mfma_f32_16x16x32_bf16 v[124:127], v[220:223], v[156:159], v[124:127]
    v_cvt_pk_bf16_f32 v58, v56, v57
    ds_write_b128 v248, v[58:61] offset:2048
    v_maximum3_f32 v52, v52, 0, 0
    v_mfma_f32_16x16x32_bf16 v[120:123], v[212:215], v[156:159], v[120:123]
    v_maximum3_f32 v53, v53, 0, 0
    v_maximum3_f32 v54, v54, 0, 0
    v_maximum3_f32 v55, v55, 0, 0
    v_mfma_f32_16x16x32_bf16 v[120:123], v[208:211], v[152:155], v[120:123]
    v_cvt_pk_bf16_f32 v52, v52, v53
    v_cvt_pk_bf16_f32 v53, v54, v55
    v_maximum3_f32 v48, v48, 0, 0
    v_mfma_f32_16x16x32_bf16 v[116:119], v[200:203], v[152:155], v[116:119]
    v_maximum3_f32 v49, v49, 0, 0
    v_maximum3_f32 v50, v50, 0, 0
    v_maximum3_f32 v51, v51, 0, 0
    v_mfma_f32_16x16x32_bf16 v[116:119], v[204:207], v[156:159], v[116:119]
    v_cvt_pk_bf16_f32 v51, v50, v51
    v_cvt_pk_bf16_f32 v50, v48, v49
    ds_write_b128 v247, v[50:53] offset:2048
    v_mfma_f32_16x16x32_bf16 v[112:115], v[196:199], v[156:159], v[112:115]
    v_maximum3_f32 v80, v80, 0, 0
    v_maximum3_f32 v81, v81, 0, 0
    v_maximum3_f32 v82, v82, 0, 0
    v_mfma_f32_16x16x32_bf16 v[112:115], v[192:195], v[152:155], v[112:115]
    v_maximum3_f32 v83, v83, 0, 0
    v_cvt_pk_bf16_f32 v83, v82, v83
    v_cvt_pk_bf16_f32 v82, v80, v81
    v_maximum3_f32 v84, v84, 0, 0
    v_maximum3_f32 v85, v85, 0, 0
    v_maximum3_f32 v86, v86, 0, 0
    v_maximum3_f32 v87, v87, 0, 0
    v_cvt_pk_bf16_f32 v84, v84, v85
    v_cvt_pk_bf16_f32 v85, v86, v87
    ds_write_b128 v247, v[82:85] offset:4096
    v_maximum3_f32 v88, v88, 0, 0
    v_maximum3_f32 v89, v89, 0, 0
    v_maximum3_f32 v90, v90, 0, 0
    v_maximum3_f32 v91, v91, 0, 0
    v_cvt_pk_bf16_f32 v91, v90, v91
    v_cvt_pk_bf16_f32 v90, v88, v89
    v_maximum3_f32 v92, v92, 0, 0
    v_maximum3_f32 v93, v93, 0, 0
    v_maximum3_f32 v94, v94, 0, 0
    v_maximum3_f32 v95, v95, 0, 0
    v_cvt_pk_bf16_f32 v92, v92, v93
    v_cvt_pk_bf16_f32 v93, v94, v95
    ds_write_b128 v248, v[90:93] offset:4096
    v_maximum3_f32 v124, v124, 0, 0
    v_maximum3_f32 v125, v125, 0, 0
    v_maximum3_f32 v126, v126, 0, 0
    v_maximum3_f32 v127, v127, 0, 0
    v_cvt_pk_bf16_f32 v124, v124, v125
    v_cvt_pk_bf16_f32 v125, v126, v127
    v_maximum3_f32 v120, v120, 0, 0
    v_maximum3_f32 v121, v121, 0, 0
    v_maximum3_f32 v122, v122, 0, 0
    v_maximum3_f32 v123, v123, 0, 0
    v_cvt_pk_bf16_f32 v123, v122, v123
    v_cvt_pk_bf16_f32 v122, v120, v121
    ds_write_b128 v248, v[122:125] offset:6144
    v_maximum3_f32 v116, v116, 0, 0
    v_maximum3_f32 v117, v117, 0, 0
    v_maximum3_f32 v118, v118, 0, 0
    v_maximum3_f32 v119, v119, 0, 0
    v_cvt_pk_bf16_f32 v116, v116, v117
    v_cvt_pk_bf16_f32 v117, v118, v119
    v_maximum3_f32 v112, v112, 0, 0
    v_maximum3_f32 v113, v113, 0, 0
    v_maximum3_f32 v114, v114, 0, 0
    v_maximum3_f32 v115, v115, 0, 0
    v_cvt_pk_bf16_f32 v115, v114, v115
    v_cvt_pk_bf16_f32 v114, v112, v113
    ds_write_b128 v247, v[114:117] offset:6144
    s_mov_b32 s35, 11
L_g2:
    s_mov_b32 s32, 32768
    s_mov_b32 s33, 4294836224
    s_mov_b32 s34, 3
    v_mov_b32 v192, 0
    v_mov_b32 v193, 0
    v_mov_b32 v194, 0
    v_mov_b32 v195, 0
    s_waitcnt lgkmcnt(0)
    s_barrier
L_g2w:
    ds_read_b128 v[128:131], v234 offset:0
    ds_read_b64_tr_b16 v[144:145], v236 offset:0
    ds_read_b64_tr_b16 v[146:147], v236 offset:1024
    ds_read_b64_tr_b16 v[148:149], v237 offset:0
    v_mfma_f32_32x32x16_bf16 v[0:15], v[192:195], v[192:195], 0
    ds_read_b64_tr_b16 v[150:151], v237 offset:1024
    ds_read_b64_tr_b16 v[152:153], v238 offset:0
    ds_read_b64_tr_b16 v[154:155], v238 offset:1024
    ds_read_b64_tr_b16 v[156:157], v239 offset:0
    ds_read_b64_tr_b16 v[158:159], v239 offset:1024
    ds_read_b128 v[132:135], v234 offset:2048
    v_mfma_f32_32x32x16_bf16 v[16:31], v[192:195], v[192:195], 0
    ds_read_b128 v[136:139], v234 offset:4096
    ds_read_b128 v[140:143], v234 offset:6144
    ds_read_b128 v[160:163], v235 offset:0
    ds_read_b64_tr_b16 v[176:177], v236 offset:8192
    ds_read_b64_tr_b16 v[178:179], v236 offset:9216
    ds_read_b64_tr_b16 v[180:181], v237 offset:8192
    v_mfma_f32_32x32x16_bf16 v[32:47], v[192:195], v[192:195], 0
    ds_read_b64_tr_b16 v[182:183], v237 offset:9216
    ds_read_b64_tr_b16 v[184:185], v238 offset:8192
    ds_read_b64_tr_b16 v[186:187], v238 offset:9216
    ds_read_b64_tr_b16 v[188:189], v239 offset:8192
    ds_read_b64_tr_b16 v[190:191], v239 offset:9216
    ds_read_b128 v[164:167], v235 offset:2048
    v_mfma_f32_32x32x16_bf16 v[48:63], v[192:195], v[192:195], 0
    ds_read_b128 v[168:171], v235 offset:4096
    ds_read_b128 v[172:175], v235 offset:6144
    s_add_u32 s34, s34, 1
    s_cmp_eq_u32 s34, 5
    s_cselect_b32 s36, s33, s32
    s_cselect_b32 s34, 0, s34
    v_add_u32_e64 v234, s36, v234
    v_add_u32_e64 v235, s36, v235
    v_add_u32_e64 v236, s36, v236
    v_add_u32_e64 v237, s36, v237
    v_add_u32_e64 v238, s36, v238
    v_add_u32_e64 v239, s36, v239
    s_waitcnt vmcnt(0)
    s_xor_b32 s36, s10, 1
    s_mov_b32 s37, 0
    s_mov_b64 exec, s[36:37]
    s_cbranch_execz L_noar
    buffer_atomic_add v244, v243, s[24:27], 0 offen sc1
L_noar:
    s_mov_b64 exec, -1
    s_waitcnt lgkmcnt(0)
    s_barrier
    s_branch LU_loop
.p2align 6
LU_top:
    v_mfma_f32_16x16x32_bf16 v[12:15], v[124:127], v[96:99], v[12:15]
    v_mfma_f32_16x16x32_bf16 v[12:15], v[92:95], v[64:67], v[12:15]
    s_waitcnt lgkmcnt(0)
    s_barrier
LU_loop:
    v_mfma_f32_16x16x32_bf16 v[0:3], v[144:147], v[128:131], v[0:3]
    ds_read_b128 v[64:67], v234 offset:0
    ds_read_b64_tr_b16 v[80:81], v236 offset:0
    v_mfma_f32_16x16x32_bf16 v[0:3], v[176:179], v[160:163], v[0:3]
    ds_read_b64_tr_b16 v[82:83], v236 offset:1024
    ds_read_b64_tr_b16 v[84:85], v237 offset:0
    v_mfma_f32_16x16x32_bf16 v[16:19], v[176:179], v[164:167], v[16:19]
    ds_read_b64_tr_b16 v[86:87], v237 offset:1024
    ds_read_b64_tr_b16 v[88:89], v238 offset:0
    v_mfma_f32_16x16x32_bf16 v[16:19], v[144:147], v[132:135], v[16:19]
    ds_read_b64_tr_b16 v[90:91], v238 offset:1024
    ds_read_b64_tr_b16 v[92:93], v239 offset:0
    v_mfma_f32_16x16x32_bf16 v[32:35], v[144:147], v[136:139], v[32:35]
    ds_read_b64_tr_b16 v[94:95], v239 offset:1024
    v_mfma_f32_16x16x32_bf16 v[32:35], v[176:179], v[168:171], v[32:35]
    ds_read_b128 v[68:71], v234 offset:2048
    v_mfma_f32_16x16x32_bf16 v[48:51], v[176:179], v[172:175], v[48:51]
    ds_read_b128 v[72:75], v234 offset:4096
    v_mfma_f32_16x16x32_bf16 v[48:51], v[144:147], v[140:143], v[48:51]
    ds_read_b128 v[76:79], v234 offset:6144
    v_mfma_f32_16x16x32_bf16 v[52:55], v[148:151], v[140:143], v[52:55]
    ds_read_b128 v[96:99], v235 offset:0
    v_mfma_f32_16x16x32_bf16 v[52:55], v[180:183], v[172:175], v[52:55]
    ds_read_b64_tr_b16 v[112:113], v236 offset:8192
    v_mfma_f32_16x16x32_bf16 v[36:39], v[180:183], v[168:171], v[36:39]
    ds_read_b64_tr_b16 v[114:115], v236 offset:9216
    v_mfma_f32_16x16x32_bf16 v[36:39], v[148:151], v[136:139], v[36:39]
    ds_read_b64_tr_b16 v[116:117], v237 offset:8192
    v_mfma_f32_16x16x32_bf16 v[20:23], v[148:151], v[132:135], v[20:23]
    ds_read_b64_tr_b16 v[118:119], v237 offset:9216
    v_mfma_f32_16x16x32_bf16 v[20:23], v[180:183], v[164:167], v[20:23]
    ds_read_b64_tr_b16 v[120:121], v238 offset:8192
    v_mfma_f32_16x16x32_bf16 v[4:7], v[180:183], v[160:163], v[4:7]
    ds_read_b64_tr_b16 v[122:123], v238 offset:9216
    v_mfma_f32_16x16x32_bf16 v[4:7], v[148:151], v[128:131], v[4:7]
    ds_read_b64_tr_b16 v[124:125], v239 offset:8192
    v_mfma_f32_16x16x32_bf16 v[8:11], v[152:155], v[128:131], v[8:11]
    ds_read_b64_tr_b16 v[126:127], v239 offset:9216
    v_mfma_f32_16x16x32_bf16 v[8:11], v[184:187], v[160:163], v[8:11]
    ds_read_b128 v[100:103], v235 offset:2048
    v_mfma_f32_16x16x32_bf16 v[24:27], v[184:187], v[164:167], v[24:27]
    ds_read_b128 v[104:107], v235 offset:4096
    v_mfma_f32_16x16x32_bf16 v[24:27], v[152:155], v[132:135], v[24:27]
    ds_read_b128 v[108:111], v235 offset:6144
    v_mfma_f32_16x16x32_bf16 v[40:43], v[152:155], v[136:139], v[40:43]
    s_add_u32 s34, s34, 1
    s_cmp_eq_u32 s34, 5
    v_mfma_f32_16x16x32_bf16 v[40:43], v[184:187], v[168:171], v[40:43]
    s_cselect_b32 s36, s33, s32
    s_cselect_b32 s34, 0, s34
    v_mfma_f32_16x16x32_bf16 v[56:59], v[184:187], v[172:175], v[56:59]
    v_add_u32_e64 v234, s36, v234
    v_mfma_f32_16x16x32_bf16 v[56:59], v[152:155], v[140:143], v[56:59]
    v_add_u32_e64 v235, s36, v235
    v_mfma_f32_16x16x32_bf16 v[60:63], v[156:159], v[140:143], v[60:63]
    v_add_u32_e64 v236, s36, v236
    v_mfma_f32_16x16x32_bf16 v[60:63], v[188:191], v[172:175], v[60:63]
    v_add_u32_e64 v237, s36, v237
    v_mfma_f32_16x16x32_bf16 v[44:47], v[188:191], v[168:171], v[44:47]
    v_add_u32_e64 v238, s36, v238
    v_mfma_f32_16x16x32_bf16 v[44:47], v[156:159], v[136:139], v[44:47]
    v_add_u32_e64 v239, s36, v239
    v_mfma_f32_16x16x32_bf16 v[28:31], v[156:159], v[132:135], v[28:31]
    v_mfma_f32_16x16x32_bf16 v[28:31], v[188:191], v[164:167], v[28:31]
    v_mfma_f32_16x16x32_bf16 v[12:15], v[188:191], v[160:163], v[12:15]
    v_mfma_f32_16x16x32_bf16 v[12:15], v[156:159], v[128:131], v[12:15]
    s_waitcnt lgkmcnt(0)
    s_barrier
LU_mid:
    v_mfma_f32_16x16x32_bf16 v[0:3], v[80:83], v[64:67], v[0:3]
    ds_read_b128 v[128:131], v234 offset:0
    ds_read_b64_tr_b16 v[144:145], v236 offset:0
    v_mfma_f32_16x16x32_bf16 v[0:3], v[112:115], v[96:99], v[0:3]
    ds_read_b64_tr_b16 v[146:147], v236 offset:1024
    ds_read_b64_tr_b16 v[148:149], v237 offset:0
    v_mfma_f32_16x16x32_bf16 v[16:19], v[112:115], v[100:103], v[16:19]
    ds_read_b64_tr_b16 v[150:151], v237 offset:1024
    ds_read_b64_tr_b16 v[152:153], v238 offset:0
    v_mfma_f32_16x16x32_bf16 v[16:19], v[80:83], v[68:71], v[16:19]
    ds_read_b64_tr_b16 v[154:155], v238 offset:1024
    ds_read_b64_tr_b16 v[156:157], v239 offset:0
    v_mfma_f32_16x16x32_bf16 v[32:35], v[80:83], v[72:75], v[32:35]
    ds_read_b64_tr_b16 v[158:159], v239 offset:1024
    v_mfma_f32_16x16x32_bf16 v[32:35], v[112:115], v[104:107], v[32:35]
    ds_read_b128 v[132:135], v234 offset:2048
    v_mfma_f32_16x16x32_bf16 v[48:51], v[112:115], v[108:111], v[48:51]
    ds_read_b128 v[136:139], v234 offset:4096
    v_mfma_f32_16x16x32_bf16 v[48:51], v[80:83], v[76:79], v[48:51]
    ds_read_b128 v[140:143], v234 offset:6144
    v_mfma_f32_16x16x32_bf16 v[52:55], v[84:87], v[76:79], v[52:55]
    ds_read_b128 v[160:163], v235 offset:0
    v_mfma_f32_16x16x32_bf16 v[52:55], v[116:119], v[108:111], v[52:55]
    ds_read_b64_tr_b16 v[176:177], v236 offset:8192
    v_mfma_f32_16x16x32_bf16 v[36:39], v[116:119], v[104:107], v[36:39]
    ds_read_b64_tr_b16 v[178:179], v236 offset:9216
    v_mfma_f32_16x16x32_bf16 v[36:39], v[84:87], v[72:75], v[36:39]
    ds_read_b64_tr_b16 v[180:181], v237 offset:8192
    v_mfma_f32_16x16x32_bf16 v[20:23], v[84:87], v[68:71], v[20:23]
    ds_read_b64_tr_b16 v[182:183], v237 offset:9216
    v_mfma_f32_16x16x32_bf16 v[20:23], v[116:119], v[100:103], v[20:23]
    ds_read_b64_tr_b16 v[184:185], v238 offset:8192
    v_mfma_f32_16x16x32_bf16 v[4:7], v[116:119], v[96:99], v[4:7]
    ds_read_b64_tr_b16 v[186:187], v238 offset:9216
    v_mfma_f32_16x16x32_bf16 v[4:7], v[84:87], v[64:67], v[4:7]
    ds_read_b64_tr_b16 v[188:189], v239 offset:8192
    v_mfma_f32_16x16x32_bf16 v[8:11], v[88:91], v[64:67], v[8:11]
    ds_read_b64_tr_b16 v[190:191], v239 offset:9216
    v_mfma_f32_16x16x32_bf16 v[8:11], v[120:123], v[96:99], v[8:11]
    ds_read_b128 v[164:167], v235 offset:2048
    v_mfma_f32_16x16x32_bf16 v[24:27], v[120:123], v[100:103], v[24:27]
    ds_read_b128 v[168:171], v235 offset:4096
    v_mfma_f32_16x16x32_bf16 v[24:27], v[88:91], v[68:71], v[24:27]
    ds_read_b128 v[172:175], v235 offset:6144
    v_mfma_f32_16x16x32_bf16 v[40:43], v[88:91], v[72:75], v[40:43]
    s_add_u32 s34, s34, 1
    s_cmp_eq_u32 s34, 5
    v_mfma_f32_16x16x32_bf16 v[40:43], v[120:123], v[104:107], v[40:43]
    s_cselect_b32 s36, s33, s32
    s_cselect_b32 s34, 0, s34
    v_mfma_f32_16x16x32_bf16 v[56:59], v[120:123], v[108:111], v[56:59]
    v_add_u32_e64 v234, s36, v234
    v_mfma_f32_16x16x32_bf16 v[56:59], v[88:91], v[76:79], v[56:59]
    v_add_u32_e64 v235, s36, v235
    v_mfma_f32_16x16x32_bf16 v[60:63], v[92:95], v[76:79], v[60:63]
    v_add_u32_e64 v236, s36, v236
    v_mfma_f32_16x16x32_bf16 v[60:63], v[124:127], v[108:111], v[60:63]
    v_add_u32_e64 v237, s36, v237
    v_mfma_f32_16x16x32_bf16 v[44:47], v[124:127], v[104:107], v[44:47]
    v_add_u32_e64 v238, s36, v238
    v_mfma_f32_16x16x32_bf16 v[44:47], v[92:95], v[72:75], v[44:47]
    v_add_u32_e64 v239, s36, v239
    v_mfma_f32_16x16x32_bf16 v[28:31], v[92:95], v[68:71], v[28:31]
    s_sub_u32 s35, s35, 1
    s_cmp_eq_u32 s35, 0
    v_mfma_f32_16x16x32_bf16 v[28:31], v[124:127], v[100:103], v[28:31]
    s_cbranch_scc0 LU_top
    v_mfma_f32_16x16x32_bf16 v[12:15], v[124:127], v[96:99], v[12:15]
    v_mfma_f32_16x16x32_bf16 v[12:15], v[92:95], v[64:67], v[12:15]
    s_waitcnt lgkmcnt(0)
    s_barrier
L_post:
    s_cmp_eq_u32 s10, 0
    s_cbranch_scc1 L_finF
    s_movk_i32 s38, 4096
    s_mov_b32 s39, 32768
    s_mov_b32 s41, 36864
    s_lshl_b32 s30, s11, 7
    s_add_u32 s30, s30, s48
    s_add_u32 s30, s30, 512
    v_mov_b32 v243, s30
    v_mfma_f32_16x16x32_bf16 v[0:3], v[144:147], v[128:131], v[0:3]
    v_mfma_f32_16x16x32_bf16 v[0:3], v[176:179], v[160:163], v[0:3]
    v_mfma_f32_16x16x32_bf16 v[4:7], v[148:151], v[128:131], v[4:7]
    v_mfma_f32_16x16x32_bf16 v[4:7], v[180:183], v[160:163], v[4:7]
    v_mfma_f32_16x16x32_bf16 v[8:11], v[152:155], v[128:131], v[8:11]
    v_mfma_f32_16x16x32_bf16 v[8:11], v[184:187], v[160:163], v[8:11]
    v_mfma_f32_16x16x32_bf16 v[12:15], v[156:159], v[128:131], v[12:15]
    v_mfma_f32_16x16x32_bf16 v[12:15], v[188:191], v[160:163], v[12:15]
    v_mfma_f32_16x16x32_bf16 v[16:19], v[144:147], v[132:135], v[16:19]
    v_mfma_f32_16x16x32_bf16 v[16:19], v[176:179], v[164:167], v[16:19]
    v_mfma_f32_16x16x32_bf16 v[20:23], v[148:151], v[132:135], v[20:23]
    v_mfma_f32_16x16x32_bf16 v[20:23], v[180:183], v[164:167], v[20:23]
    buffer_store_dwordx4 v[0:3], v242, s[24:27], 0 offen offset:0 sc1
    v_mfma_f32_16x16x32_bf16 v[24:27], v[152:155], v[132:135], v[24:27]
    v_mfma_f32_16x16x32_bf16 v[24:27], v[184:187], v[164:167], v[24:27]
    buffer_store_dwordx4 v[4:7], v242, s[24:27], 0 offen offset:1024 sc1
    v_mfma_f32_16x16x32_bf16 v[28:31], v[156:159], v[132:135], v[28:31]
    v_mfma_f32_16x16x32_bf16 v[28:31], v[188:191], v[164:167], v[28:31]
    buffer_store_dwordx4 v[8:11], v242, s[24:27], 0 offen offset:2048 sc1
    v_mfma_f32_16x16x32_bf16 v[32:35], v[144:147], v[136:139], v[32:35]
    v_mfma_f32_16x16x32_bf16 v[32:35], v[176:179], v[168:171], v[32:35]
    buffer_store_dwordx4 v[12:15], v242, s[24:27], 0 offen offset:3072 sc1
    v_mfma_f32_16x16x32_bf16 v[36:39], v[148:151], v[136:139], v[36:39]
    v_mfma_f32_16x16x32_bf16 v[36:39], v[180:183], v[168:171], v[36:39]
    buffer_store_dwordx4 v[16:19], v242, s[24:27], s38 offen offset:0 sc1
    v_mfma_f32_16x16x32_bf16 v[40:43], v[152:155], v[136:139], v[40:43]
    v_mfma_f32_16x16x32_bf16 v[40:43], v[184:187], v[168:171], v[40:43]
    buffer_store_dwordx4 v[20:23], v242, s[24:27], s38 offen offset:1024 sc1
    v_mfma_f32_16x16x32_bf16 v[44:47], v[156:159], v[136:139], v[44:47]
    v_mfma_f32_16x16x32_bf16 v[44:47], v[188:191], v[168:171], v[44:47]
    buffer_store_dwordx4 v[24:27], v242, s[24:27], s38 offen offset:2048 sc1
    v_mfma_f32_16x16x32_bf16 v[48:51], v[144:147], v[140:143], v[48:51]
    v_mfma_f32_16x16x32_bf16 v[48:51], v[176:179], v[172:175], v[48:51]
    buffer_store_dwordx4 v[28:31], v242, s[24:27], s38 offen offset:3072 sc1
    v_mfma_f32_16x16x32_bf16 v[52:55], v[148:151], v[140:143], v[52:55]
    v_mfma_f32_16x16x32_bf16 v[52:55], v[180:183], v[172:175], v[52:55]
    buffer_store_dwordx4 v[32:35], v242, s[24:27], s39 offen offset:0 sc1
    v_mfma_f32_16x16x32_bf16 v[56:59], v[152:155], v[140:143], v[56:59]
    v_mfma_f32_16x16x32_bf16 v[56:59], v[184:187], v[172:175], v[56:59]
    buffer_store_dwordx4 v[36:39], v242, s[24:27], s39 offen offset:1024 sc1
    v_mfma_f32_16x16x32_bf16 v[60:63], v[156:159], v[140:143], v[60:63]
    v_mfma_f32_16x16x32_bf16 v[60:63], v[188:191], v[172:175], v[60:63]
    buffer_store_dwordx4 v[40:43], v242, s[24:27], s39 offen offset:2048 sc1
    s_nop 7
    buffer_store_dwordx4 v[44:47], v242, s[24:27], s39 offen offset:3072 sc1
    buffer_store_dwordx4 v[48:51], v242, s[24:27], s41 offen offset:0 sc1
    buffer_store_dwordx4 v[52:55], v242, s[24:27], s41 offen offset:1024 sc1
    s_waitcnt vmcnt(6)
    s_mov_b64 exec, 1
    buffer_atomic_add v244, v243, s[24:27], 0 offen sc1
    s_mov_b64 exec, -1
    buffer_store_dwordx4 v[56:59], v242, s[24:27], s41 offen offset:2048 sc1
    buffer_store_dwordx4 v[60:63], v242, s[24:27], s41 offen offset:3072 sc1
    v_mov_b32 v244, 16
    s_waitcnt vmcnt(0)
    s_mov_b64 exec, 1
    buffer_atomic_add v244, v243, s[24:27], 0 offen sc1
    s_mov_b64 exec, -1
L_finH:
    s_endpgm
L_finF:
    v_add_u32 v245, 32768, v241
    v_add_u32 v246, 65536, v241
    s_mov_b32 s32, 32768
    s_mov_b32 s33, 65536
    s_mov_b32 s34, 98304
    v_mfma_f32_16x16x32_bf16 v[0:3], v[144:147], v[128:131], v[0:3]
    v_and_b32 v247, 15, v240
    v_mul_u32_u24 v247, 136, v247
    v_mfma_f32_16x16x32_bf16 v[0:3], v[176:179], v[160:163], v[0:3]
    v_lshrrev_b32 v248, 4, v240
    v_lshl_add_u32 v247, v248, 3, v247
    v_mfma_f32_16x16x32_bf16 v[4:7], v[148:151], v[128:131], v[4:7]
    s_lshl_b32 s30, s12, 13
    s_add_u32 s31, s30, 65536
    v_mfma_f32_16x16x32_bf16 v[4:7], v[180:183], v[160:163], v[4:7]
    s_add_u32 s30, s30, 32768
    v_add_u32 v248, s31, v247
    v_mfma_f32_16x16x32_bf16 v[8:11], v[152:155], v[128:131], v[8:11]
    v_add_u32 v247, s30, v247
    v_lshrrev_b32 v251, 3, v240
    v_mfma_f32_16x16x32_bf16 v[8:11], v[184:187], v[160:163], v[8:11]
    v_and_b32 v252, 7, v240
    v_mul_u32_u24 v249, 136, v251
    v_mfma_f32_16x16x32_bf16 v[12:15], v[156:159], v[128:131], v[12:15]
    v_lshl_add_u32 v249, v252, 4, v249
    v_add_u32 v250, s31, v249
    v_mfma_f32_16x16x32_bf16 v[12:15], v[188:191], v[160:163], v[12:15]
    v_add_u32 v249, s30, v249
    s_mov_b32 s30, s43
    s_barrier
    v_mfma_f32_16x16x32_bf16 v[16:19], v[144:147], v[132:135], v[16:19]
    ds_read_b128 v[64:67], v245 offset:0
    ds_read_b128 v[68:71], v245 offset:1024
    v_mfma_f32_16x16x32_bf16 v[16:19], v[176:179], v[164:167], v[16:19]
    ds_read_b128 v[72:75], v245 offset:2048
    ds_read_b128 v[76:79], v245 offset:3072
    v_mfma_f32_16x16x32_bf16 v[20:23], v[148:151], v[132:135], v[20:23]
    ds_read_b128 v[80:83], v245 offset:4096
    ds_read_b128 v[84:87], v245 offset:5120
    v_mfma_f32_16x16x32_bf16 v[20:23], v[180:183], v[164:167], v[20:23]
    ds_read_b128 v[88:91], v245 offset:6144
    ds_read_b128 v[92:95], v245 offset:7168
    v_mfma_f32_16x16x32_bf16 v[24:27], v[152:155], v[132:135], v[24:27]
    v_lshlrev_b32 v251, 11, v251
    v_lshl_add_u32 v251, v252, 4, v251
    v_mfma_f32_16x16x32_bf16 v[24:27], v[184:187], v[164:167], v[24:27]
    v_add_u32 v253, 2176, v249
    v_add_u32 v254, 2176, v250
    v_mfma_f32_16x16x32_bf16 v[28:31], v[156:159], v[132:135], v[28:31]
    v_add_u32 v242, s30, v251
    v_add_u32 v251, 16384, v242
    v_mfma_f32_16x16x32_bf16 v[28:31], v[188:191], v[164:167], v[28:31]
    v_mfma_f32_16x16x32_bf16 v[32:35], v[144:147], v[136:139], v[32:35]
    v_mfma_f32_16x16x32_bf16 v[32:35], v[176:179], v[168:171], v[32:35]
    v_mfma_f32_16x16x32_bf16 v[36:39], v[148:151], v[136:139], v[36:39]
    v_mfma_f32_16x16x32_bf16 v[36:39], v[180:183], v[168:171], v[36:39]
    s_waitcnt lgkmcnt(0)
    v_mfma_f32_16x16x32_bf16 v[40:43], v[152:155], v[136:139], v[40:43]
    v_pk_add_f32 v[0:1], v[0:1], v[64:65]
    v_pk_add_f32 v[2:3], v[2:3], v[66:67]
    v_mfma_f32_16x16x32_bf16 v[40:43], v[184:187], v[168:171], v[40:43]
    v_cvt_pk_bf16_f32 v0, v0, v1
    v_cvt_pk_bf16_f32 v1, v2, v3
    v_mfma_f32_16x16x32_bf16 v[44:47], v[156:159], v[136:139], v[44:47]
    ds_write_b64 v247, v[0:1] offset:0
    v_pk_add_f32 v[4:5], v[4:5], v[68:69]
    v_mfma_f32_16x16x32_bf16 v[44:47], v[188:191], v[168:171], v[44:47]
    v_pk_add_f32 v[6:7], v[6:7], v[70:71]
    v_cvt_pk_bf16_f32 v4, v4, v5
    v_mfma_f32_16x16x32_bf16 v[48:51], v[144:147], v[140:143], v[48:51]
    v_cvt_pk_bf16_f32 v5, v6, v7
    ds_write_b64 v247, v[4:5] offset:32
    v_mfma_f32_16x16x32_bf16 v[48:51], v[176:179], v[172:175], v[48:51]
    v_pk_add_f32 v[8:9], v[8:9], v[72:73]
    v_pk_add_f32 v[10:11], v[10:11], v[74:75]
    v_mfma_f32_16x16x32_bf16 v[52:55], v[148:151], v[140:143], v[52:55]
    v_cvt_pk_bf16_f32 v8, v8, v9
    v_cvt_pk_bf16_f32 v9, v10, v11
    v_mfma_f32_16x16x32_bf16 v[52:55], v[180:183], v[172:175], v[52:55]
    ds_write_b64 v247, v[8:9] offset:64
    v_pk_add_f32 v[12:13], v[12:13], v[76:77]
    v_mfma_f32_16x16x32_bf16 v[56:59], v[152:155], v[140:143], v[56:59]
    v_pk_add_f32 v[14:15], v[14:15], v[78:79]
    v_cvt_pk_bf16_f32 v12, v12, v13
    v_mfma_f32_16x16x32_bf16 v[56:59], v[184:187], v[172:175], v[56:59]
    v_cvt_pk_bf16_f32 v13, v14, v15
    ds_write_b64 v247, v[12:13] offset:96
    v_mfma_f32_16x16x32_bf16 v[60:63], v[156:159], v[140:143], v[60:63]
    ds_read2_b64 v[192:195], v249 offset0:0 offset1:1
    ds_read2_b64 v[196:199], v249 offset0:136 offset1:137
    v_mfma_f32_16x16x32_bf16 v[60:63], v[188:191], v[172:175], v[60:63]
    v_pk_add_f32 v[16:17], v[16:17], v[80:81]
    v_pk_add_f32 v[18:19], v[18:19], v[82:83]
    v_cvt_pk_bf16_f32 v16, v16, v17
    v_cvt_pk_bf16_f32 v17, v18, v19
    ds_write_b64 v247, v[16:17] offset:2176
    v_pk_add_f32 v[20:21], v[20:21], v[84:85]
    v_pk_add_f32 v[22:23], v[22:23], v[86:87]
    v_cvt_pk_bf16_f32 v20, v20, v21
    v_cvt_pk_bf16_f32 v21, v22, v23
    ds_write_b64 v247, v[20:21] offset:2208
    v_pk_add_f32 v[24:25], v[24:25], v[88:89]
    v_pk_add_f32 v[26:27], v[26:27], v[90:91]
    v_cvt_pk_bf16_f32 v24, v24, v25
    v_cvt_pk_bf16_f32 v25, v26, v27
    ds_write_b64 v247, v[24:25] offset:2240
    v_pk_add_f32 v[28:29], v[28:29], v[92:93]
    v_pk_add_f32 v[30:31], v[30:31], v[94:95]
    v_cvt_pk_bf16_f32 v28, v28, v29
    v_cvt_pk_bf16_f32 v29, v30, v31
    ds_write_b64 v247, v[28:29] offset:2272
    ds_read2_b64 v[200:203], v253 offset0:0 offset1:1
    ds_read2_b64 v[204:207], v253 offset0:136 offset1:137
    s_waitcnt lgkmcnt(6)
    buffer_store_dwordx4 v[192:195], v242, s[20:23], 0 offen sc1
    buffer_store_dwordx4 v[196:199], v251, s[20:23], 0 offen sc1
    s_barrier
    ds_read_b128 v[96:99], v246 offset:0
    ds_read_b128 v[100:103], v246 offset:1024
    ds_read_b128 v[104:107], v246 offset:2048
    ds_read_b128 v[108:111], v246 offset:3072
    ds_read_b128 v[112:115], v246 offset:4096
    ds_read_b128 v[116:119], v246 offset:5120
    ds_read_b128 v[120:123], v246 offset:6144
    ds_read_b128 v[124:127], v246 offset:7168
    s_waitcnt lgkmcnt(8)
    buffer_store_dwordx4 v[200:203], v242, s[20:23], s32 offen sc1
    buffer_store_dwordx4 v[204:207], v251, s[20:23], s32 offen sc1
    s_waitcnt lgkmcnt(0)
    v_pk_add_f32 v[32:33], v[32:33], v[96:97]
    v_pk_add_f32 v[34:35], v[34:35], v[98:99]
    v_cvt_pk_bf16_f32 v32, v32, v33
    v_cvt_pk_bf16_f32 v33, v34, v35
    ds_write_b64 v248, v[32:33] offset:0
    v_pk_add_f32 v[36:37], v[36:37], v[100:101]
    v_pk_add_f32 v[38:39], v[38:39], v[102:103]
    v_cvt_pk_bf16_f32 v36, v36, v37
    v_cvt_pk_bf16_f32 v37, v38, v39
    ds_write_b64 v248, v[36:37] offset:32
    v_pk_add_f32 v[40:41], v[40:41], v[104:105]
    v_pk_add_f32 v[42:43], v[42:43], v[106:107]
    v_cvt_pk_bf16_f32 v40, v40, v41
    v_cvt_pk_bf16_f32 v41, v42, v43
    ds_write_b64 v248, v[40:41] offset:64
    v_pk_add_f32 v[44:45], v[44:45], v[108:109]
    v_pk_add_f32 v[46:47], v[46:47], v[110:111]
    v_cvt_pk_bf16_f32 v44, v44, v45
    v_cvt_pk_bf16_f32 v45, v46, v47
    ds_write_b64 v248, v[44:45] offset:96
    ds_read2_b64 v[208:211], v250 offset0:0 offset1:1
    ds_read2_b64 v[212:215], v250 offset0:136 offset1:137
    v_pk_add_f32 v[48:49], v[48:49], v[112:113]
    v_pk_add_f32 v[50:51], v[50:51], v[114:115]
    v_cvt_pk_bf16_f32 v48, v48, v49
    v_cvt_pk_bf16_f32 v49, v50, v51
    ds_write_b64 v248, v[48:49] offset:2176
    v_pk_add_f32 v[52:53], v[52:53], v[116:117]
    v_pk_add_f32 v[54:55], v[54:55], v[118:119]
    v_cvt_pk_bf16_f32 v52, v52, v53
    v_cvt_pk_bf16_f32 v53, v54, v55
    ds_write_b64 v248, v[52:53] offset:2208
    v_pk_add_f32 v[56:57], v[56:57], v[120:121]
    v_pk_add_f32 v[58:59], v[58:59], v[122:123]
    v_cvt_pk_bf16_f32 v56, v56, v57
    v_cvt_pk_bf16_f32 v57, v58, v59
    ds_write_b64 v248, v[56:57] offset:2240
    v_pk_add_f32 v[60:61], v[60:61], v[124:125]
    v_pk_add_f32 v[62:63], v[62:63], v[126:127]
    v_cvt_pk_bf16_f32 v60, v60, v61
    v_cvt_pk_bf16_f32 v61, v62, v63
    ds_write_b64 v248, v[60:61] offset:2272
    ds_read2_b64 v[216:219], v254 offset0:0 offset1:1
    ds_read2_b64 v[220:223], v254 offset0:136 offset1:137
    s_waitcnt lgkmcnt(6)
    buffer_store_dwordx4 v[208:211], v242, s[20:23], s33 offen sc1
    buffer_store_dwordx4 v[212:215], v251, s[20:23], s33 offen sc1
    s_waitcnt lgkmcnt(0)
    buffer_store_dwordx4 v[216:219], v242, s[20:23], s34 offen sc1
    buffer_store_dwordx4 v[220:223], v251, s[20:23], s34 offen sc1
    s_branch L_finH
.p2align 6
.type L_tab,@object
L_tab:
.byte 0,1,2,6,3,4,5,10,7,8,9,11,22,19,20,21,23,43,40,41,42,47,44,45,46,51,48,49,50,55,52,53,54,0,0,0,0,0,0,0,0,0,0,0,0,0,0,0,0,0,0,0,0,0,0,0,0,0,0,0,0,0,0,0
.byte 0,1,2,3,7,4,5,6,11,8,9,10,19,23,20,21,22,40,44,41,42,43,48,45,46,47,52,49,50,51,53,54,55,0,0,0,0,0,0,0,0,0,0,0,0,0,0,0,0,0,0,0,0,0,0,0,0,0,0,0,0,0,0,0
.byte 0,1,2,3,4,8,5,6,7,9,10,11,19,20,21,22,23,40,41,45,42,43,44,49,46,47,48,53,50,51,52,54,55,0,0,0,0,0,0,0,0,0,0,0,0,0,0,0,0,0,0,0,0,0,0,0,0,0,0,0,0,0,0,0
.byte 0,1,2,3,4,5,9,6,7,8,10,11,19,20,21,22,23,40,41,42,46,43,44,45,50,47,48,49,54,51,52,53,55,0,0,0,0,0,0,0,0,0,0,0,0,0,0,0,0,0,0,0,0,0,0,0,0,0,0,0,0,0,0,0
.byte 3,4,5,6,0,1,2,10,7,8,9,11,22,19,20,21,23,43,40,41,42,47,44,45,46,51,48,49,50,55,52,53,54,0,0,0,0,0,0,0,0,0,0,0,0,0,0,0,0,0,0,0,0,0,0,0,0,0,0,0,0,0,0,0
.byte 3,4,5,0,7,1,2,6,11,8,9,10,19,23,20,21,22,40,44,41,42,43,48,45,46,47,52,49,50,51,53,54,55,0,0,0,0,0,0,0,0,0,0,0,0,0,0,0,0,0,0,0,0,0,0,0,0,0,0,0,0,0,0,0
.byte 3,4,5,0,1,8,2,6,7,9,10,11,19,20,21,22,23,40,41,45,42,43,44,49,46,47,48,53,50,51,52,54,55,0,0,0,0,0,0,0,0,0,0,0,0,0,0,0,0,0,0,0,0,0,0,0,0,0,0,0,0,0,0,0
.byte 3,4,5,0,1,2,9,6,7,8,10,11,19,20,21,22,23,40,41,42,46,43,44,45,50,47,48,49,54,51,52,53,55,0,0,0,0,0,0,0,0,0,0,0,0,0,0,0,0,0,0,0,0,0,0,0,0,0,0,0,0,0,0,0
.byte 6,7,8,3,0,1,2,10,4,5,9,11,22,19,20,21,23,43,40,41,42,47,44,45,46,51,48,49,50,55,52,53,54,0,0,0,0,0,0,0,0,0,0,0,0,0,0,0,0,0,0,0,0,0,0,0,0,0,0,0,0,0,0,0
.byte 6,7,8,0,4,1,2,3,11,5,9,10,19,23,20,21,22,40,44,41,42,43,48,45,46,47,52,49,50,51,53,54,55,0,0,0,0,0,0,0,0,0,0,0,0,0,0,0,0,0,0,0,0,0,0,0,0,0,0,0,0,0,0,0
.byte 6,7,8,0,1,5,2,3,4,9,10,11,19,20,21,22,23,40,41,45,42,43,44,49,46,47,48,53,50,51,52,54,55,0,0,0,0,0,0,0,0,0,0,0,0,0,0,0,0,0,0,0,0,0,0,0,0,0,0,0,0,0,0,0
.byte 6,7,8,0,1,2,9,3,4,5,10,11,19,20,21,22,23,40,41,42,46,43,44,45,50,47,48,49,54,51,52,53,55,0,0,0,0,0,0,0,0,0,0,0,0,0,0,0,0,0,0,0,0,0,0,0,0,0,0,0,0,0,0,0
.byte 9,10,11,3,0,1,2,7,4,5,6,8,22,19,20,21,23,43,40,41,42,47,44,45,46,51,48,49,50,55,52,53,54,0,0,0,0,0,0,0,0,0,0,0,0,0,0,0,0,0,0,0,0,0,0,0,0,0,0,0,0,0,0,0
.byte 9,10,11,0,4,1,2,3,8,5,6,7,19,23,20,21,22,40,44,41,42,43,48,45,46,47,52,49,50,51,53,54,55,0,0,0,0,0,0,0,0,0,0,0,0,0,0,0,0,0,0,0,0,0,0,0,0,0,0,0,0,0,0,0
.byte 9,10,11,0,1,5,2,3,4,6,7,8,19,20,21,22,23,40,41,45,42,43,44,49,46,47,48,53,50,51,52,54,55,0,0,0,0,0,0,0,0,0,0,0,0,0,0,0,0,0,0,0,0,0,0,0,0,0,0,0,0,0,0,0
.byte 9,10,11,0,1,2,6,3,4,5,7,8,19,20,21,22,23,40,41,42,46,43,44,45,50,47,48,49,54,51,52,53,55,0,0,0,0,0,0,0,0,0,0,0,0,0,0,0,0,0,0,0,0,0,0,0,0,0,0,0,0,0,0,0
.byte 12,13,14,18,15,16,17,22,19,20,21,23,10,7,8,9,11,27,24,25,26,31,28,29,30,35,32,33,34,39,36,37,38,0,0,0,0,0,0,0,0,0,0,0,0,0,0,0,0,0,0,0,0,0,0,0,0,0,0,0,0,0,0,0
.byte 12,13,14,15,19,16,17,18,23,20,21,22,7,11,8,9,10,24,28,25,26,27,32,29,30,31,36,33,34,35,37,38,39,0,0,0,0,0,0,0,0,0,0,0,0,0,0,0,0,0,0,0,0,0,0,0,0,0,0,0,0,0,0,0
.byte 12,13,14,15,16,20,17,18,19,21,22,23,7,8,9,10,11,24,25,29,26,27,28,33,30,31,32,37,34,35,36,38,39,0,0,0,0,0,0,0,0,0,0,0,0,0,0,0,0,0,0,0,0,0,0,0,0,0,0,0,0,0,0,0
.byte 12,13,14,15,16,17,21,18,19,20,22,23,7,8,9,10,11,24,25,26,30,27,28,29,34,31,32,33,38,35,36,37,39,0,0,0,0,0,0,0,0,0,0,0,0,0,0,0,0,0,0,0,0,0,0,0,0,0,0,0,0,0,0,0
.byte 15,16,17,18,12,13,14,22,19,20,21,23,10,7,8,9,11,27,24,25,26,31,28,29,30,35,32,33,34,39,36,37,38,0,0,0,0,0,0,0,0,0,0,0,0,0,0,0,0,0,0,0,0,0,0,0,0,0,0,0,0,0,0,0
.byte 15,16,17,12,19,13,14,18,23,20,21,22,7,11,8,9,10,24,28,25,26,27,32,29,30,31,36,33,34,35,37,38,39,0,0,0,0,0,0,0,0,0,0,0,0,0,0,0,0,0,0,0,0,0,0,0,0,0,0,0,0,0,0,0
.byte 15,16,17,12,13,20,14,18,19,21,22,23,7,8,9,10,11,24,25,29,26,27,28,33,30,31,32,37,34,35,36,38,39,0,0,0,0,0,0,0,0,0,0,0,0,0,0,0,0,0,0,0,0,0,0,0,0,0,0,0,0,0,0,0
.byte 15,16,17,12,13,14,21,18,19,20,22,23,7,8,9,10,11,24,25,26,30,27,28,29,34,31,32,33,38,35,36,37,39,0,0,0,0,0,0,0,0,0,0,0,0,0,0,0,0,0,0,0,0,0,0,0,0,0,0,0,0,0,0,0
.byte 18,19,20,15,12,13,14,22,16,17,21,23,10,7,8,9,11,27,24,25,26,31,28,29,30,35,32,33,34,39,36,37,38,0,0,0,0,0,0,0,0,0,0,0,0,0,0,0,0,0,0,0,0,0,0,0,0,0,0,0,0,0,0,0
.byte 18,19,20,12,16,13,14,15,23,17,21,22,7,11,8,9,10,24,28,25,26,27,32,29,30,31,36,33,34,35,37,38,39,0,0,0,0,0,0,0,0,0,0,0,0,0,0,0,0,0,0,0,0,0,0,0,0,0,0,0,0,0,0,0
.byte 18,19,20,12,13,17,14,15,16,21,22,23,7,8,9,10,11,24,25,29,26,27,28,33,30,31,32,37,34,35,36,38,39,0,0,0,0,0,0,0,0,0,0,0,0,0,0,0,0,0,0,0,0,0,0,0,0,0,0,0,0,0,0,0
.byte 18,19,20,12,13,14,21,15,16,17,22,23,7,8,9,10,11,24,25,26,30,27,28,29,34,31,32,33,38,35,36,37,39,0,0,0,0,0,0,0,0,0,0,0,0,0,0,0,0,0,0,0,0,0,0,0,0,0,0,0,0,0,0,0
.byte 21,22,23,15,12,13,14,19,16,17,18,20,10,7,8,9,11,27,24,25,26,31,28,29,30,35,32,33,34,39,36,37,38,0,0,0,0,0,0,0,0,0,0,0,0,0,0,0,0,0,0,0,0,0,0,0,0,0,0,0,0,0,0,0
.byte 21,22,23,12,16,13,14,15,20,17,18,19,7,11,8,9,10,24,28,25,26,27,32,29,30,31,36,33,34,35,37,38,39,0,0,0,0,0,0,0,0,0,0,0,0,0,0,0,0,0,0,0,0,0,0,0,0,0,0,0,0,0,0,0
.byte 21,22,23,12,13,17,14,15,16,18,19,20,7,8,9,10,11,24,25,29,26,27,28,33,30,31,32,37,34,35,36,38,39,0,0,0,0,0,0,0,0,0,0,0,0,0,0,0,0,0,0,0,0,0,0,0,0,0,0,0,0,0,0,0
.byte 21,22,23,12,13,14,18,15,16,17,19,20,7,8,9,10,11,24,25,26,30,27,28,29,34,31,32,33,38,35,36,37,39,0,0,0,0,0,0,0,0,0,0,0,0,0,0,0,0,0,0,0,0,0,0,0,0,0,0,0,0,0,0,0
.byte 24,25,26,27,15,12,13,14,16,17,18,31,28,29,30,35,32,33,34,39,36,37,38,0,0,0,0,0,0,0,0,0,0,0,0,0,0,0,0,0,0,0,0,0,0,0,0,0,0,0,0,0,0,0,0,0,0,0,0,0,0,0,0,0
.byte 24,25,26,27,12,16,13,14,15,17,18,28,32,29,30,31,36,33,34,35,37,38,39,0,0,0,0,0,0,0,0,0,0,0,0,0,0,0,0,0,0,0,0,0,0,0,0,0,0,0,0,0,0,0,0,0,0,0,0,0,0,0,0,0
.byte 24,25,26,27,12,13,17,14,15,16,18,28,29,33,30,31,32,37,34,35,36,38,39,0,0,0,0,0,0,0,0,0,0,0,0,0,0,0,0,0,0,0,0,0,0,0,0,0,0,0,0,0,0,0,0,0,0,0,0,0,0,0,0,0
.byte 24,25,26,27,12,13,14,18,15,16,17,28,29,30,34,31,32,33,38,35,36,37,39,0,0,0,0,0,0,0,0,0,0,0,0,0,0,0,0,0,0,0,0,0,0,0,0,0,0,0,0,0,0,0,0,0,0,0,0,0,0,0,0,0
.byte 28,29,30,31,15,12,13,14,16,17,18,27,24,25,26,35,32,33,34,39,36,37,38,0,0,0,0,0,0,0,0,0,0,0,0,0,0,0,0,0,0,0,0,0,0,0,0,0,0,0,0,0,0,0,0,0,0,0,0,0,0,0,0,0
.byte 28,29,30,31,12,16,13,14,15,17,18,24,32,25,26,27,36,33,34,35,37,38,39,0,0,0,0,0,0,0,0,0,0,0,0,0,0,0,0,0,0,0,0,0,0,0,0,0,0,0,0,0,0,0,0,0,0,0,0,0,0,0,0,0
.byte 28,29,30,31,12,13,17,14,15,16,18,24,25,33,26,27,32,37,34,35,36,38,39,0,0,0,0,0,0,0,0,0,0,0,0,0,0,0,0,0,0,0,0,0,0,0,0,0,0,0,0,0,0,0,0,0,0,0,0,0,0,0,0,0
.byte 28,29,30,31,12,13,14,18,15,16,17,24,25,26,34,27,32,33,38,35,36,37,39,0,0,0,0,0,0,0,0,0,0,0,0,0,0,0,0,0,0,0,0,0,0,0,0,0,0,0,0,0,0,0,0,0,0,0,0,0,0,0,0,0
.byte 32,33,34,35,15,12,13,14,16,17,18,27,24,25,26,31,28,29,30,39,36,37,38,0,0,0,0,0,0,0,0,0,0,0,0,0,0,0,0,0,0,0,0,0,0,0,0,0,0,0,0,0,0,0,0,0,0,0,0,0,0,0,0,0
.byte 32,33,34,35,12,16,13,14,15,17,18,24,28,25,26,27,36,29,30,31,37,38,39,0,0,0,0,0,0,0,0,0,0,0,0,0,0,0,0,0,0,0,0,0,0,0,0,0,0,0,0,0,0,0,0,0,0,0,0,0,0,0,0,0
.byte 32,33,34,35,12,13,17,14,15,16,18,24,25,29,26,27,28,37,30,31,36,38,39,0,0,0,0,0,0,0,0,0,0,0,0,0,0,0,0,0,0,0,0,0,0,0,0,0,0,0,0,0,0,0,0,0,0,0,0,0,0,0,0,0
.byte 32,33,34,35,12,13,14,18,15,16,17,24,25,26,30,27,28,29,38,31,36,37,39,0,0,0,0,0,0,0,0,0,0,0,0,0,0,0,0,0,0,0,0,0,0,0,0,0,0,0,0,0,0,0,0,0,0,0,0,0,0,0,0,0
.byte 36,37,38,39,15,12,13,14,16,17,18,27,24,25,26,31,28,29,30,35,32,33,34,0,0,0,0,0,0,0,0,0,0,0,0,0,0,0,0,0,0,0,0,0,0,0,0,0,0,0,0,0,0,0,0,0,0,0,0,0,0,0,0,0
.byte 36,37,38,39,12,16,13,14,15,17,18,24,28,25,26,27,32,29,30,31,33,34,35,0,0,0,0,0,0,0,0,0,0,0,0,0,0,0,0,0,0,0,0,0,0,0,0,0,0,0,0,0,0,0,0,0,0,0,0,0,0,0,0,0
.byte 36,37,38,39,12,13,17,14,15,16,18,24,25,29,26,27,28,33,30,31,32,34,35,0,0,0,0,0,0,0,0,0,0,0,0,0,0,0,0,0,0,0,0,0,0,0,0,0,0,0,0,0,0,0,0,0,0,0,0,0,0,0,0,0
.byte 36,37,38,39,12,13,14,18,15,16,17,24,25,26,30,27,28,29,34,31,32,33,35,0,0,0,0,0,0,0,0,0,0,0,0,0,0,0,0,0,0,0,0,0,0,0,0,0,0,0,0,0,0,0,0,0,0,0,0,0,0,0,0,0
.byte 40,41,42,43,3,0,1,2,4,5,6,47,44,45,46,51,48,49,50,55,52,53,54,0,0,0,0,0,0,0,0,0,0,0,0,0,0,0,0,0,0,0,0,0,0,0,0,0,0,0,0,0,0,0,0,0,0,0,0,0,0,0,0,0
.byte 40,41,42,43,0,4,1,2,3,5,6,44,48,45,46,47,52,49,50,51,53,54,55,0,0,0,0,0,0,0,0,0,0,0,0,0,0,0,0,0,0,0,0,0,0,0,0,0,0,0,0,0,0,0,0,0,0,0,0,0,0,0,0,0
.byte 40,41,42,43,0,1,5,2,3,4,6,44,45,49,46,47,48,53,50,51,52,54,55,0,0,0,0,0,0,0,0,0,0,0,0,0,0,0,0,0,0,0,0,0,0,0,0,0,0,0,0,0,0,0,0,0,0,0,0,0,0,0,0,0
.byte 40,41,42,43,0,1,2,6,3,4,5,44,45,46,50,47,48,49,54,51,52,53,55,0,0,0,0,0,0,0,0,0,0,0,0,0,0,0,0,0,0,0,0,0,0,0,0,0,0,0,0,0,0,0,0,0,0,0,0,0,0,0,0,0
.byte 44,45,46,47,3,0,1,2,4,5,6,43,40,41,42,51,48,49,50,55,52,53,54,0,0,0,0,0,0,0,0,0,0,0,0,0,0,0,0,0,0,0,0,0,0,0,0,0,0,0,0,0,0,0,0,0,0,0,0,0,0,0,0,0
.byte 44,45,46,47,0,4,1,2,3,5,6,40,48,41,42,43,52,49,50,51,53,54,55,0,0,0,0,0,0,0,0,0,0,0,0,0,0,0,0,0,0,0,0,0,0,0,0,0,0,0,0,0,0,0,0,0,0,0,0,0,0,0,0,0
.byte 44,45,46,47,0,1,5,2,3,4,6,40,41,49,42,43,48,53,50,51,52,54,55,0,0,0,0,0,0,0,0,0,0,0,0,0,0,0,0,0,0,0,0,0,0,0,0,0,0,0,0,0,0,0,0,0,0,0,0,0,0,0,0,0
.byte 44,45,46,47,0,1,2,6,3,4,5,40,41,42,50,43,48,49,54,51,52,53,55,0,0,0,0,0,0,0,0,0,0,0,0,0,0,0,0,0,0,0,0,0,0,0,0,0,0,0,0,0,0,0,0,0,0,0,0,0,0,0,0,0
.byte 48,49,50,51,3,0,1,2,4,5,6,43,40,41,42,47,44,45,46,55,52,53,54,0,0,0,0,0,0,0,0,0,0,0,0,0,0,0,0,0,0,0,0,0,0,0,0,0,0,0,0,0,0,0,0,0,0,0,0,0,0,0,0,0
.byte 48,49,50,51,0,4,1,2,3,5,6,40,44,41,42,43,52,45,46,47,53,54,55,0,0,0,0,0,0,0,0,0,0,0,0,0,0,0,0,0,0,0,0,0,0,0,0,0,0,0,0,0,0,0,0,0,0,0,0,0,0,0,0,0
.byte 48,49,50,51,0,1,5,2,3,4,6,40,41,45,42,43,44,53,46,47,52,54,55,0,0,0,0,0,0,0,0,0,0,0,0,0,0,0,0,0,0,0,0,0,0,0,0,0,0,0,0,0,0,0,0,0,0,0,0,0,0,0,0,0
.byte 48,49,50,51,0,1,2,6,3,4,5,40,41,42,46,43,44,45,54,47,52,53,55,0,0,0,0,0,0,0,0,0,0,0,0,0,0,0,0,0,0,0,0,0,0,0,0,0,0,0,0,0,0,0,0,0,0,0,0,0,0,0,0,0
.byte 52,53,54,55,3,0,1,2,4,5,6,43,40,41,42,47,44,45,46,51,48,49,50,0,0,0,0,0,0,0,0,0,0,0,0,0,0,0,0,0,0,0,0,0,0,0,0,0,0,0,0,0,0,0,0,0,0,0,0,0,0,0,0,0
.byte 52,53,54,55,0,4,1,2,3,5,6,40,44,41,42,43,48,45,46,47,49,50,51,0,0,0,0,0,0,0,0,0,0,0,0,0,0,0,0,0,0,0,0,0,0,0,0,0,0,0,0,0,0,0,0,0,0,0,0,0,0,0,0,0
.byte 52,53,54,55,0,1,5,2,3,4,6,40,41,45,42,43,44,49,46,47,48,50,51,0,0,0,0,0,0,0,0,0,0,0,0,0,0,0,0,0,0,0,0,0,0,0,0,0,0,0,0,0,0,0,0,0,0,0,0,0,0,0,0,0
.byte 52,53,54,55,0,1,2,6,3,4,5,40,41,42,46,43,44,45,50,47,48,49,51,0,0,0,0,0,0,0,0,0,0,0,0,0,0,0,0,0,0,0,0,0,0,0,0,0,0,0,0,0,0,0,0,0,0,0,0,0,0,0,0,0
L_tabend:
.size L_tab, 4096
.section .rodata,"a"
.p2align 6
.amdhsa_kernel standalone__dense_activation_relu__prompt_kernel
  .amdhsa_next_free_vgpr 256
  .amdhsa_next_free_sgpr 102
  .amdhsa_accum_offset 256
  .amdhsa_group_segment_fixed_size 0
  .amdhsa_kernarg_size 48
  .amdhsa_user_sgpr_count 2
  .amdhsa_user_sgpr_kernarg_segment_ptr 1
  .amdhsa_system_sgpr_workgroup_id_x 1
.end_amdhsa_kernel
```
